```python
import torch

def _softmax(x, axis=-1):
    return torch.softmax(x, dim=axis)
def _gelu(x):
    return torch.nn.functional.gelu(x, approximate="tanh")
def _silu(x):
    return torch.nn.functional.silu(x)
def _sigmoid(x):
    return torch.sigmoid(x)
def _layernorm(x, axis=-1, eps=1e-5):
    m = x.mean(dim=axis, keepdim=True)
    v = x.var(dim=axis, keepdim=True, unbiased=False)
    return (x - m) / torch.sqrt(v + eps)
def _scatter_add(tgt, idx, src, axis=0):
    return tgt.clone().index_add_(axis, idx, src)
def _segment_sum(src, seg, n):
    out = torch.zeros((n,) + src.shape[1:], dtype=src.dtype)
    return out.index_add_(0, seg, src)
def _pad(x, pw):
    flat = tuple(v for pair in reversed(pw) for v in pair)
    return torch.nn.functional.pad(x, flat)

kernel_name = 'concat_heads__spectral_gfnet__ssm_conv_h3__prompt'

def setup_inputs():

    _w = (lambda a: (lambda t: t.to(torch.bfloat16) if t.is_floating_point() else t)(torch.as_tensor(a)))
    def _A_setup():
        B, S, D = 1, 2048, 640
        Df = D // 2 + 1
        return {
            "x": _w((lambda *s: torch.randn(*s, dtype=torch.bfloat16) * 0.05)(B, S, D)),
            "w_r": _w((lambda *s: torch.randn(*s, dtype=torch.bfloat16) * 0.05)(S, Df) * 0.02),
            "w_i": _w((lambda *s: torch.randn(*s, dtype=torch.bfloat16) * 0.05)(S, Df) * 0.02),
        }
    _A_in = _A_setup()

    def _B_setup():
        B, S, D = 1, 2048, 640
        ks = 4
        return {
            "q": _w((lambda *s: torch.randn(*s, dtype=torch.bfloat16) * 0.05)(B, S, D)),
            "k": _w((lambda *s: torch.randn(*s, dtype=torch.bfloat16) * 0.1)(B, S, D)),
            "v": _w((lambda *s: torch.randn(*s, dtype=torch.bfloat16) * 0.1)(B, S, D)),
            "shift_k": _w((lambda *s: torch.randn(*s, dtype=torch.bfloat16) * 0.1)(D, ks) * 0.5),
            "ssm_k": _w((lambda *s: torch.randn(*s, dtype=torch.bfloat16) * 0.1)(D, S) * (1.0 / S ** 0.5)),
            "ssm_D": _w((lambda *s: torch.randn(*s, dtype=torch.bfloat16) * 0.1)(D)),
        }
    _B_in = _B_setup()

    return {
        "A_x": _A_in["x"],
        "A_w_r": _A_in["w_r"],
        "A_w_i": _A_in["w_i"],
        "B_q": _B_in["q"],
        "B_k": _B_in["k"],
        "B_v": _B_in["v"],
        "B_shift_k": _B_in["shift_k"],
        "B_ssm_k": _B_in["ssm_k"],
        "B_ssm_D": _B_in["ssm_D"],
    }

def reference(A_x, A_w_r, A_w_i, B_q, B_k, B_v, B_shift_k, B_ssm_k, B_ssm_D):
    def _A_ref(x, w_r, w_i):
        B, S, D = x.shape
        X = (lambda x, axes=(-2,-1): torch.fft.rfft2(x.float(), dim=axes))(x, axes=(-2, -1))
        W = w_r + 1j * w_i
        X = X * W
        y = (lambda x, s, axes=(-2,-1): torch.fft.irfft2(x, s=s, dim=axes).to(torch.bfloat16))(X, (S, D), axes=(-2, -1))
        return y

    def _B_ref(q, k, v, shift_k, ssm_k, ssm_D):
        B, S, D = q.shape
        ks = shift_k.shape[-1]
        k_pad = _pad(k, ((0, 0), (ks - 1, 0), (0, 0)))
        k_shift = torch.zeros_like(k)
        for t in range(ks):
            k_shift = k_shift + k_pad[:, t:t + S, :] * shift_k[:, ks - 1 - t][None, None, :]
        kv = k_shift * v
        L = 2 * S
        kv_pad = _pad(kv, ((0, 0), (0, S), (0, 0)))
        kf_pad = _pad(ssm_k, ((0, 0), (0, S)))
        kv_f = (lambda x, axes=(-2,-1): torch.fft.rfft2(x.float(), dim=axes))(kv_pad[:, None, :, :], axes=(1, 2))
        kf_f = (lambda x, axes=(-2,-1): torch.fft.rfft2(x.float(), dim=axes))(kf_pad[:, None, :], axes=(1, 2))
        kf_f = (lambda x, *d: x.permute(*d))(kf_f, 1, 2, 0)
        y_f = kv_f * kf_f[None, :, :, :]
        y = (lambda x, s, axes=(-2,-1): torch.fft.irfft2(x, s=s, dim=axes).to(torch.bfloat16))(y_f, (1, L), axes=(1, 2))[:, 0, :S, :]
        y = y + kv * ssm_D[None, None, :]
        return q * y

    a = _A_ref(A_x, A_w_r, A_w_i)
    b = _B_ref(B_q, B_k, B_v, B_shift_k, B_ssm_k, B_ssm_D)
    return torch.concatenate([a, b], axis=-1)
```

```asm
; @launch grid=(256,1,1) block=(768,1,1) lds=163840
.amdgcn_target "amdgcn-amd-amdhsa--gfx950"
.text
.globl concat_heads__spectral_gfnet__ssm_conv_h3__prompt_kernel
.p2align 12
.type concat_heads__spectral_gfnet__ssm_conv_h3__prompt_kernel,@function
concat_heads__spectral_gfnet__ssm_conv_h3__prompt_kernel:
    s_cmp_ge_u32 s2, 256
    s_cbranch_scc1 Lexit
    s_load_dwordx16 s[16:31], s[0:1], 0
    s_load_dwordx8 s[32:39], s[0:1], 64
    s_getpc_b64 s[42:43]
    s_and_b32 s42, s42, 4294963200
    s_bitcmp1_b32 s2, 3
    s_cselect_b32 s8, 11264, 0
    s_add_u32 s42, s42, s8
    s_addc_u32 s43, s43, 0
    v_lshlrev_b32 v2, 4, v0
    v_mov_b32 v3, s43
    v_add_co_u32 v2, vcc, s42, v2
    s_nop 1
    v_addc_co_u32 v3, vcc, 0, v3, vcc
    global_load_dwordx4 v[164:167], v[2:3], off
    v_lshrrev_b32 v1, 6, v0
    v_and_b32 v0, 63, v0
    v_readfirstlane_b32 s3, v1
    s_and_b32 s4, s2, 7
    s_bfe_u32 s5, s2, 65539
    s_lshr_b32 s6, s2, 4
    s_lshl3_add_u32 s7, s6, s4
    s_mov_b32 s100, 4294901759
    s_mov_b32 s101, 65536
    s_mul_i32 s53, s4, 80
    s_mul_i32 s8, s6, 5
    s_add_u32 s53, s53, s8
    s_lshl1_add_u32 s53, s5, s53
    v_lshlrev_b32 v1, 2, v0
    v_mov_b32 v2, 0
    ds_write_b32 v1, v2 offset:0
    s_cmp_lg_u32 s5, 0
    s_cbranch_scc1 LentO
    s_cmp_ge_u32 s3, 8
    s_cbranch_scc1 LentP
    s_lshl_b32 s9, s3, 7
    s_add_u32 s9, s9, s7
    s_mul_i32 s10, s9, 1280
    v_lshlrev_b32 v4, 4, v0
    v_add_u32 v1, s10, v4
    v_add_u32 v2, 1309312, v1
    v_cmp_gt_u32 vcc, 24, v0
    s_nop 1
    v_cndmask_b32 v2, v2, v1, vcc
    v_min_u32 v4, 624, v4
    v_add_u32 v4, 1309312, v4
    v_add_u32 v3, s10, v4
    s_mul_i32 s11, s3, 3072
    s_add_u32 s11, s11, 139264
    s_mov_b32 m0, s11
    s_waitcnt lgkmcnt(0)
    global_load_lds_dwordx4 v1, s[16:17] offset:0
    global_load_lds_dwordx4 v2, s[16:17] offset:1024
    global_load_lds_dwordx4 v3, s[16:17] offset:2048
    s_branch LA1
LentP:
    s_mul_i32 s10, s6, 163840
    s_mul_i32 s8, s4, 160
    s_add_u32 s10, s10, s8
    s_bitcmp1_b32 s3, 0
    s_cselect_b32 s8, 156, 0
    s_add_u32 s10, s10, s8
    s_add_u32 s10, s10, 81920
    v_mul_u32_u24 v1, 1280, v0
    v_add_u32 v1, s10, v1
    s_bitcmp1_b32 s3, 1
    s_waitcnt lgkmcnt(0)
    s_cselect_b64 s[12:13], s[26:27], s[24:25]
    global_load_dword v163, v1, s[12:13]
    s_add_u32 s8, s53, 2
    s_lshl_b32 s8, s8, 12
    s_sub_u32 s9, s3, 8
    s_mul_i32 s9, s9, 3072
    s_add_u32 s8, s8, s9
    v_min_u32 v1, 23, v0
    v_lshl_add_u32 v1, v1, 7, s8
    global_load_dword v162, v1, s[30:31]
    s_branch Lbar0
LentO:
    s_cmp_ge_u32 s3, 9
    s_cbranch_scc1 Lbar0
    v_mul_u32_u24 v2, 26, v0
    v_lshrrev_b32 v2, 8, v2
    v_mul_u32_u24 v1, 1120, v2
    v_lshl_add_u32 v1, v0, 4, v1
    s_mul_i32 s10, s6, 163840
    s_mul_i32 s8, s4, 160
    s_add_u32 s10, s10, s8
    s_sub_u32 s8, s10, 5120
    v_add_u32 v3, s8, v1
    s_waitcnt lgkmcnt(0)
    s_mov_b32 s44, s24
    s_and_b32 s45, s25, 65535
    s_mov_b32 s46, 2621440
    s_mov_b32 s47, 131072
    s_mov_b32 s48, s26
    s_and_b32 s49, s27, 65535
    s_mov_b32 s50, 2621440
    s_mov_b32 s51, 131072
    s_mov_b32 exec_hi, 255
    s_cmp_eq_u32 s3, 8
    s_cbranch_scc1 LentH
    s_mul_i32 s11, s3, 10240
    s_add_u32 s11, s11, s10
    s_mul_i32 s12, s3, 1296
    s_add_u32 s12, s12, 117520
    s_mov_b32 m0, s12
    s_nop 0
    buffer_load_dwordx4 v1, s[44:47], s11 offen lds
    s_add_u32 m0, s12, 20736
    s_nop 0
    buffer_load_dwordx4 v1, s[48:51], s11 offen lds
    s_addk_i32 s11, 5120
    s_addk_i32 s12, 640
    s_mov_b32 m0, s12
    s_nop 0
    buffer_load_dwordx4 v1, s[44:47], s11 offen lds
    s_add_u32 m0, s12, 20736
    s_nop 0
    buffer_load_dwordx4 v1, s[48:51], s11 offen lds
    s_add_u32 s11, s11, 76800
    s_addk_i32 s12, 9728
    s_mov_b32 m0, s12
    s_nop 0
    buffer_load_dwordx4 v1, s[44:47], s11 offen lds
    s_add_u32 m0, s12, 20736
    s_nop 0
    buffer_load_dwordx4 v1, s[48:51], s11 offen lds
    s_addk_i32 s11, 5120
    s_addk_i32 s12, 640
    s_mov_b32 m0, s12
    s_nop 0
    buffer_load_dwordx4 v1, s[44:47], s11 offen lds
    s_add_u32 m0, s12, 20736
    s_nop 0
    buffer_load_dwordx4 v1, s[48:51], s11 offen lds
    s_branch LentX
LentH:
    s_mov_b32 m0, 116864
    s_nop 0
    buffer_load_dwordx4 v3, s[44:47], 0 offen lds
LentX:
    s_mov_b64 exec, -1
Lbar0:
    s_waitcnt lgkmcnt(0)
    s_lshl_b32 s96, s53, 1
    s_and_b32 s96, s96, -4
    s_min_u32 s96, s96, 1272
    s_load_dwordx2 s[54:55], s[32:33], s96
    s_barrier
    s_cmp_eq_u32 s5, 0
    s_cbranch_scc1 LauxE
    s_cmp_ge_u32 s3, 10
    s_cbranch_scc1 LauxO
    s_branch LB1
Lexit:
    s_endpgm
LA1:
    s_setprio 2
    s_mul_i32 s10, s3, 2880
    s_add_u32 s10, s10, 116224
    v_lshrrev_b32 v5, 4, v0
    v_mul_u32_u24 v5, 640, v5
    v_lshl_add_u32 v5, v0, 2, v5
    v_add_u32 v5, s10, v5
    v_mov_b32 v6, 0
    ds_write_b32 v5, v6 offset:640
    v_and_b32 v5, 15, v0
    v_lshrrev_b32 v6, 4, v0
    v_mul_u32_u24 v5, 5, v5
    s_mov_b32 s12, s3
    s_nop 0
Lc1:
    s_cmp_ge_u32 s12, 11
    s_cbranch_scc1 Lc2
    s_cmp_ge_u32 s12, 5
    s_cselect_b32 s13, 2, 1
    s_cselect_b32 s14, 5, 0
    s_sub_u32 s14, s12, s14
    s_cmp_eq_u32 s12, 10
    s_cselect_b32 s13, 0, s13
    v_add_u32 v8, s13, v5
    v_cvt_f32_u32 v8, v8
    v_mul_f32 v8, 0x3c4ccccd, v8
    v_lshlrev_b32 v7, 2, v6
    v_cvt_f32_u32 v7, v7
    s_mul_i32 s8, s13, s14
    v_cvt_f32_u32 v9, s8
    v_mul_f32 v9, 0x3e4ccccd, v9
    v_fma_f32 v12, v8, v7, v9
    v_add_f32 v13, v12, v8
    v_add_f32 v14, v13, v8
    v_add_f32 v15, v14, v8
    v_cos_f32 v16, v12
    v_sin_f32 v20, v12
    v_cos_f32 v17, v13
    v_sin_f32 v21, v13
    v_cos_f32 v18, v14
    v_sin_f32 v22, v14
    v_cos_f32 v19, v15
    v_sin_f32 v23, v15
    v_cvt_pk_bf16_f32 v24, v16, v17
    v_cvt_pk_bf16_f32 v26, -v20, -v21
    v_cvt_pk_bf16_f32 v25, v18, v19
    v_cvt_pk_bf16_f32 v27, -v22, -v23
    s_sub_u32 s15, s13, 1
    s_lshl_b32 s8, s15, 2
    s_add_u32 s8, s8, s14
    s_add_u32 s15, s15, 8
    s_cmp_eq_u32 s14, 4
    s_cselect_b32 s8, s15, s8
    s_cmp_eq_u32 s12, 10
    s_cselect_b32 s8, 10, s8
    s_cselect_b32 s41, 8, 0
    s_lshr_b32 s15, s8, 1
    s_lshl_b32 s15, s15, 10
    s_and_b32 s8, s8, 1
    s_lshl3_add_u32 s8, s8, s15
    s_add_u32 s8, s8, 23040
    v_lshl_add_u32 v10, v0, 4, s8
    v_add_u32 v9, s41, v10
    ds_write_b64 v10, v[24:25]
    ds_write_b64 v10, v[26:27] offset:30976
    ds_write_b64 v9, v[24:25]
    ds_write_b64 v9, v[26:27] offset:30976
    s_branch Lc3
Lc2:
    s_sub_u32 s13, s12, 11
    v_add_u32 v8, s13, v5
    v_cvt_f32_u32 v8, v8
    v_mul_f32 v8, 0x3acccccd, v8
    v_and_b32 v7, 1, v6
    v_lshlrev_b32 v7, 2, v7
    v_cvt_f32_u32 v7, v7
    v_mul_f32 v12, v8, v7
    v_add_f32 v13, v12, v8
    v_add_f32 v14, v13, v8
    v_add_f32 v15, v14, v8
    v_cos_f32 v16, v12
    v_sin_f32 v20, v12
    v_cos_f32 v17, v13
    v_sin_f32 v21, v13
    v_cos_f32 v18, v14
    v_sin_f32 v22, v14
    v_cos_f32 v19, v15
    v_sin_f32 v23, v15
    s_mul_i32 s8, s13, 30976
    s_add_u32 s8, s8, 29184
    s_cmp_eq_u32 s13, 2
    s_cselect_b32 s8, 17168, s8
    v_lshl_add_u32 v10, v0, 4, s8
    ds_write_b128 v10, v[16:19]
    ds_write_b128 v10, v[20:23] offset:1024
Lc3:
    s_add_u32 s12, s12, 8
    s_cmp_lt_u32 s12, 14
    s_cbranch_scc1 Lc1
    s_waitcnt lgkmcnt(0)
    s_lshl_b32 s96, s53, 1
    s_and_b32 s96, s96, -4
    s_min_u32 s96, s96, 1272
    s_load_dwordx2 s[54:55], s[32:33], s96
    s_barrier
    v_lshlrev_b32 v2, 4, v0
    v_add_u32 v1, 23040, v2
    v_add_u32 v2, 17168, v2
    v_and_b32 v104, 7, v0
    v_cvt_f32_u32 v104, v104
    v_mul_f32 v104, 0x3e000000, v104
    v_bfe_u32 v106, v0, 3, 1
    v_lshrrev_b32 v105, 5, v0
    v_lshl_add_u32 v105, v105, 10, s9
    v_mul_u32_u24 v105, v105, v106
    v_cvt_f32_u32 v105, v105
    v_mul_f32 v105, 0x3a000000, v105
    v_lshlrev_b32 v111, 29, v0
    v_and_b32 v111, 2147483648, v111
    v_xor_b32 v105, v105, v111
    v_bfe_u32 v106, v0, 4, 1
    v_lshlrev_b32 v106, 2, v106
    v_cvt_f32_u32 v106, v106
    v_fma_f32 v107, v104, v106, v105
    v_lshrrev_b32 v106, 16, v111
    v_or_b32 v106, v106, v111
    v_add_f32 v108, v107, v104
    v_add_f32 v109, v108, v104
    v_add_f32 v110, v109, v104
    v_cos_f32 v111, v107
    v_sin_f32 v115, v107
    v_cos_f32 v112, v108
    v_sin_f32 v116, v108
    v_cos_f32 v113, v109
    v_sin_f32 v117, v109
    v_cos_f32 v114, v110
    v_sin_f32 v118, v110
    v_cvt_pk_bf16_f32 v88, v111, v115
    v_cvt_pk_bf16_f32 v92, -v115, v111
    v_xor_b32 v92, v106, v92
    v_cvt_pk_bf16_f32 v89, v112, v116
    v_cvt_pk_bf16_f32 v93, -v116, v112
    v_xor_b32 v93, v106, v93
    v_cvt_pk_bf16_f32 v90, v113, v117
    v_cvt_pk_bf16_f32 v94, -v117, v113
    v_xor_b32 v94, v106, v94
    v_cvt_pk_bf16_f32 v91, v114, v118
    v_cvt_pk_bf16_f32 v95, -v118, v114
    v_xor_b32 v95, v106, v95
    s_waitcnt lgkmcnt(0)
    ds_read_b128 v[32:35], v1 offset:4096
    ds_read_b128 v[56:59], v1 offset:35072
    ds_read_b128 v[16:19], v1 offset:0
    ds_read_b128 v[40:43], v1 offset:30976
    ds_read_b128 v[20:23], v1 offset:1024
    ds_read_b128 v[44:47], v1 offset:32000
    ds_read_b128 v[24:27], v1 offset:2048
    ds_read_b128 v[48:51], v1 offset:33024
    ds_read_b128 v[28:31], v1 offset:3072
    ds_read_b128 v[52:55], v1 offset:34048
    ds_read_b128 v[36:39], v1 offset:5120
    ds_read_b128 v[60:63], v1 offset:36096
    ds_read_b128 v[72:75], v1 offset:37120
    ds_read_b128 v[76:79], v1 offset:38144
    ds_read_b128 v[80:83], v2 offset:0
    ds_read_b128 v[64:67], v1 offset:6144
    ds_read_b128 v[84:87], v2 offset:1024
    ds_read_b128 v[68:71], v1 offset:7168
    v_lshrrev_b32 v3, 4, v0
    v_bfe_u32 v4, v0, 1, 1
    v_mul_u32_u24 v4, 1408, v4
    v_and_b32 v1, 1, v0
    v_lshl_add_u32 v4, v1, 3, v4
    v_lshrrev_b32 v1, 2, v0
    v_lshl_add_u32 v4, v1, 4, v4
    v_add_u32 v4, s11, v4
    v_and_b32 v1, 1, v0
    v_lshrrev_b32 v2, 5, v0
    v_sub_u32 v1, v1, v2
    v_cvt_f32_i32 v151, v1
    v_mul_f32 v151, 0x3e800000, v151
    v_bfe_u32 v1, v0, 1, 1
    v_bfe_u32 v2, v0, 4, 1
    v_cmp_eq_u32 vcc, v1, v2
    s_nop 1
    v_cndmask_b32 v12, 0, -1, vcc
    v_cvt_f32_u32 v1, s7
    v_mul_f32 v1, 0x3c000000, v1
    v_bfe_u32 v150, v0, 2, 2
    v_cvt_f32_u32 v150, v150
    v_mul_f32 v150, 0x3e000000, v150
    v_fma_f32 v152, v150, v1, v151
    v_cos_f32 v153, v152
    v_add_f32 v152, v152, v150
    v_cos_f32 v154, v152
    v_add_f32 v152, v152, v150
    v_cvt_pk_bf16_f32 v96, v153, v154
    v_and_b32 v96, v12, v96
    v_cos_f32 v153, v152
    v_add_f32 v152, v152, v150
    v_cos_f32 v154, v152
    v_add_f32 v152, v152, v150
    v_cvt_pk_bf16_f32 v97, v153, v154
    v_and_b32 v97, v12, v97
    v_cos_f32 v153, v152
    v_add_f32 v152, v152, v150
    v_cos_f32 v154, v152
    v_add_f32 v152, v152, v150
    v_cvt_pk_bf16_f32 v98, v153, v154
    v_and_b32 v98, v12, v98
    v_cos_f32 v153, v152
    v_add_f32 v152, v152, v150
    v_cos_f32 v154, v152
    s_nop 0
    v_cvt_pk_bf16_f32 v99, v153, v154
    v_and_b32 v99, v12, v99
    v_bfe_u32 v150, v0, 2, 2
    v_add_u32 v150, 4, v150
    v_cvt_f32_u32 v150, v150
    v_mul_f32 v150, 0x3e000000, v150
    v_fma_f32 v152, v150, v1, v151
    v_cos_f32 v153, v152
    v_add_f32 v152, v152, v150
    v_cos_f32 v154, v152
    v_add_f32 v152, v152, v150
    v_cvt_pk_bf16_f32 v100, v153, v154
    v_and_b32 v100, v12, v100
    v_cos_f32 v153, v152
    v_add_f32 v152, v152, v150
    v_cos_f32 v154, v152
    v_add_f32 v152, v152, v150
    v_cvt_pk_bf16_f32 v101, v153, v154
    v_and_b32 v101, v12, v101
    v_cos_f32 v153, v152
    v_add_f32 v152, v152, v150
    v_cos_f32 v154, v152
    v_add_f32 v152, v152, v150
    v_cvt_pk_bf16_f32 v102, v153, v154
    v_and_b32 v102, v12, v102
    v_cos_f32 v153, v152
    v_add_f32 v152, v152, v150
    v_cos_f32 v154, v152
    s_nop 0
    v_cvt_pk_bf16_f32 v103, v153, v154
    v_and_b32 v103, v12, v103
    v_mov_b32 v8, 76
    v_mov_b32 v9, 1
    s_waitcnt vmcnt(0)
    ds_read_b64_tr_b16 v[136:137], v4 offset:1024
    ds_read_b64_tr_b16 v[128:129], v4 offset:0
    ds_read_b64_tr_b16 v[130:131], v4 offset:256
    ds_read_b64_tr_b16 v[132:133], v4 offset:512
    ds_read_b64_tr_b16 v[134:135], v4 offset:768
    s_mov_b64 exec, 1
    ds_add_u32 v8, v9
    s_mov_b64 exec, -1
    v_and_b32 v1, 7, v0
    v_lshl_add_u32 v1, v1, 2, v3
    v_sub_u32 v2, 31, v1
    v_cmp_gt_u32 vcc, 16, v1
    v_min_u32 v2, v1, v2
    v_mul_u32_u24 v5, 40, v2
    v_add_u32 v6, 32, v5
    v_add_u32 v2, 16, v5
    v_cndmask_b32 v5, v2, v5, vcc
    v_mov_b32 v2, 656
    v_cndmask_b32 v6, v2, v6, vcc
    v_cmp_eq_u32 vcc, 16, v1
    v_mov_b32 v2, 640
    s_nop 0
    v_cndmask_b32 v6, v6, v2, vcc
    v_and_b32 v2, 15, v1
    v_cmp_eq_u32 vcc, 0, v2
    s_nop 1
    v_cndmask_b32 v11, 1.0, 0.5, vcc
    s_waitcnt lgkmcnt(5)
    v_mfma_f32_16x16x16_bf16 v[112:115], v[136:137], v[32:33], 0
    v_mfma_f32_16x16x16_bf16 v[116:119], v[136:137], v[56:57], 0
    v_mfma_f32_16x16x16_bf16 v[120:123], v[136:137], v[34:35], 0
    v_mfma_f32_16x16x16_bf16 v[124:127], v[136:137], v[58:59], 0
    v_mfma_f32_16x16x16_bf16 v[104:107], v[136:137], v[36:37], 0
    v_mfma_f32_16x16x16_bf16 v[108:111], v[136:137], v[60:61], 0
    v_bfe_u32 v2, v0, 3, 1
    v_mul_u32_u24 v2, 1408, v2
    v_add_u32 v2, s10, v2
    v_add_u32 v5, v5, v2
    v_add_u32 v6, v6, v2
    s_waitcnt lgkmcnt(3)
    v_mfma_f32_16x16x32_bf16 v[112:115], v[128:131], v[16:19], v[112:115]
    v_mfma_f32_16x16x32_bf16 v[116:119], v[128:131], v[40:43], v[116:119]
    s_waitcnt lgkmcnt(1)
    v_mfma_f32_16x16x32_bf16 v[112:115], v[132:135], v[20:23], v[112:115]
    v_mfma_f32_16x16x32_bf16 v[116:119], v[132:135], v[44:47], v[116:119]
    s_mul_i32 s8, s7, 20608
    s_and_b32 s12, s3, 1
    s_mul_i32 s13, s12, 1280
    s_lshr_b32 s14, s3, 1
    s_lshl_b32 s14, s14, 7
    s_add_u32 s13, s13, s14
    s_add_u32 s13, s13, s8
    v_lshrrev_b32 v1, 4, v0
    v_mul_u32_u24 v8, 2432, v1
    v_lshl_add_u32 v8, v0, 3, v8
    v_add_u32 v8, s13, v8
    v_add_u32 v9, 10240, v8
    s_lshl2_add_u32 s8, s12, s8
    s_add_u32 s8, s8, 20480
    v_lshl_add_u32 v10, v1, 3, s8
    v_mfma_f32_16x16x32_bf16 v[120:123], v[128:131], v[24:27], v[120:123]
    v_mfma_f32_16x16x32_bf16 v[124:127], v[128:131], v[48:51], v[124:127]
    v_mfma_f32_16x16x32_bf16 v[120:123], v[132:135], v[28:31], v[120:123]
    v_mfma_f32_16x16x32_bf16 v[124:127], v[132:135], v[52:55], v[124:127]
    v_bfe_u32 v7, v0, 2, 2
    v_mul_u32_u24 v7, 2880, v7
    v_and_b32 v1, 3, v0
    v_lshl_add_u32 v7, v1, 3, v7
    v_and_b32 v1, 1, v3
    v_lshl_add_u32 v7, v1, 5, v7
    v_lshrrev_b32 v1, 5, v0
    v_mul_u32_u24 v1, 704, v1
    v_add_u32 v7, v7, v1
    s_mul_i32 s8, s12, 1408
    s_lshr_b32 s14, s14, 1
    s_add_u32 s8, s8, s14
    s_add_u32 s8, s8, 116224
    v_add_u32 v7, s8, v7
    v_mfma_f32_16x16x32_bf16 v[104:107], v[128:131], v[36:39], v[104:107]
    v_mfma_f32_16x16x32_bf16 v[108:111], v[128:131], v[60:63], v[108:111]
    v_mfma_f32_16x16x32_bf16 v[104:107], v[132:135], v[36:39], v[104:107]
    v_mfma_f32_16x16x32_bf16 v[108:111], v[132:135], v[60:63], v[108:111]
    v_mul_f32 v150, v112, v72
    v_mul_f32 v154, v116, v72
    v_fmac_f32 v150, v116, v76
    v_fma_f32 v154, -v112, v76, v154
    v_cvt_pk_bf16_f32 v142, v150, v154
    v_mul_f32 v151, v113, v73
    v_mul_f32 v155, v117, v73
    v_fmac_f32 v151, v117, v77
    v_fma_f32 v155, -v113, v77, v155
    v_cvt_pk_bf16_f32 v143, v151, v155
    v_mul_f32 v152, v114, v74
    v_mul_f32 v156, v118, v74
    v_fmac_f32 v152, v118, v78
    v_fma_f32 v156, -v114, v78, v156
    v_cvt_pk_bf16_f32 v144, v152, v156
    v_mul_f32 v153, v115, v75
    v_mul_f32 v157, v119, v75
    v_fmac_f32 v153, v119, v79
    v_fma_f32 v157, -v115, v79, v157
    v_cvt_pk_bf16_f32 v145, v153, v157
    s_nop 1
    v_mfma_f32_16x16x32_bf16 v[24:27], v[142:145], v[88:91], 0
    v_mfma_f32_16x16x32_bf16 v[28:31], v[142:145], v[92:95], 0
    v_mul_f32 v150, v120, v80
    v_mul_f32 v154, v124, v80
    v_fmac_f32 v150, v124, v84
    v_fma_f32 v154, -v120, v84, v154
    v_cvt_pk_bf16_f32 v146, v150, v154
    v_mul_f32 v151, v121, v81
    v_mul_f32 v155, v125, v81
    v_fmac_f32 v151, v125, v85
    v_fma_f32 v155, -v121, v85, v155
    v_cvt_pk_bf16_f32 v147, v151, v155
    v_mul_f32 v152, v122, v82
    v_mul_f32 v156, v126, v82
    v_fmac_f32 v152, v126, v86
    v_fma_f32 v156, -v122, v86, v156
    v_cvt_pk_bf16_f32 v148, v152, v156
    v_mul_f32 v153, v123, v83
    v_mul_f32 v157, v127, v83
    v_fmac_f32 v153, v127, v87
    v_fma_f32 v157, -v123, v87, v157
    v_cvt_pk_bf16_f32 v149, v153, v157
    s_nop 1
    v_mfma_f32_16x16x32_bf16 v[32:35], v[146:149], v[88:91], 0
    v_mfma_f32_16x16x32_bf16 v[36:39], v[146:149], v[92:95], 0
    v_mul_f32 v150, v104, v64
    v_mul_f32 v154, v108, v64
    v_fmac_f32 v150, v108, v68
    v_fma_f32 v154, -v104, v68, v154
    v_cvt_pk_bf16_f32 v138, v150, v154
    v_mul_f32 v151, v105, v65
    v_mul_f32 v155, v109, v65
    v_fmac_f32 v151, v109, v69
    v_fma_f32 v155, -v105, v69, v155
    v_cvt_pk_bf16_f32 v139, v151, v155
    v_mul_f32 v152, v106, v66
    v_mul_f32 v156, v110, v66
    v_fmac_f32 v152, v110, v70
    v_fma_f32 v156, -v106, v70, v156
    v_cvt_pk_bf16_f32 v140, v152, v156
    v_mul_f32 v153, v107, v67
    v_mul_f32 v157, v111, v67
    v_fmac_f32 v153, v111, v71
    v_fma_f32 v157, -v107, v71, v157
    v_cvt_pk_bf16_f32 v141, v153, v157
    s_nop 1
    v_mfma_f32_16x16x32_bf16 v[16:19], v[138:141], v[88:91], 0
    v_mfma_f32_16x16x32_bf16 v[20:23], v[138:141], v[92:95], 0
    v_cvt_pk_bf16_f32 v138, v24, v32
    v_cvt_pk_bf16_f32 v139, v25, v33
    v_cvt_pk_bf16_f32 v140, v26, v34
    v_cvt_pk_bf16_f32 v141, v27, v35
    ds_write_b64 v5, v[138:139] offset:0
    ds_write_b64 v5, v[140:141] offset:8
    v_cvt_pk_bf16_f32 v142, v28, v36
    v_cvt_pk_bf16_f32 v143, v29, v37
    v_cvt_pk_bf16_f32 v144, v30, v38
    v_cvt_pk_bf16_f32 v145, v31, v39
    ds_write_b64 v5, v[142:143] offset:704
    ds_write_b64 v5, v[144:145] offset:712
    v_mul_f32 v16, v11, v16
    v_cvt_pk_bf16_f32 v146, v16, v17
    v_cvt_pk_bf16_f32 v147, v18, v19
    ds_write_b64 v6, v[146:147] offset:0
    v_mul_f32 v20, v11, v20
    v_cvt_pk_bf16_f32 v148, v20, v21
    v_cvt_pk_bf16_f32 v149, v22, v23
    ds_write_b64 v6, v[148:149] offset:704
    v_mov_b32 v12, 4294901758
    v_and_b32 v13, 1, v0
    v_lshlrev_b32 v13, 16, v13
    v_or_b32 v14, 1, v13
    v_mov_b32 v1, 0
    v_mov_b32 v2, 1
    s_waitcnt lgkmcnt(0)
    s_mov_b64 exec, 1
    ds_add_rtn_u32 v2, v1, v2
    s_mov_b64 exec, -1
    s_waitcnt lgkmcnt(0)
    v_readfirstlane_b32 s40, v2
    s_cmp_ge_u32 s40, 7
    s_cbranch_scc1 Lbd4
Lbl5:
    ds_read_b32 v2, v1
    s_waitcnt lgkmcnt(0)
    v_readfirstlane_b32 s40, v2
    s_cmp_lt_u32 s40, 8
    s_cbranch_scc1 Lbl5
Lbd4:
    ds_read_b64_tr_b16 v[64:65], v7 offset:0
    ds_read_b64_tr_b16 v[66:67], v7 offset:11520
    ds_read_b64_tr_b16 v[68:69], v7 offset:256
    ds_read_b64_tr_b16 v[70:71], v7 offset:11776
    ds_read_b64_tr_b16 v[72:73], v7 offset:512
    ds_read_b64_tr_b16 v[74:75], v7 offset:12032
    s_waitcnt lgkmcnt(4)
    v_mfma_f32_16x16x32_bf16 v[104:107], v[96:99], v[64:67], 0
    v_mfma_f32_16x16x32_bf16 v[108:111], v[100:103], v[64:67], 0
    s_waitcnt lgkmcnt(2)
    v_mfma_f32_16x16x32_bf16 v[112:115], v[96:99], v[68:71], 0
    v_mfma_f32_16x16x32_bf16 v[116:119], v[100:103], v[68:71], 0
    s_waitcnt lgkmcnt(0)
    v_mfma_f32_16x16x32_bf16 v[120:123], v[96:99], v[72:75], 0
    v_mfma_f32_16x16x32_bf16 v[124:127], v[100:103], v[72:75], 0
    s_nop 0
    v_cvt_pk_bf16_f32 v138, v104, v105
    v_cvt_pk_bf16_f32 v139, v106, v107
    v_and_or_b32 v138, v138, v12, v13
    v_and_or_b32 v139, v139, v12, v14
    global_store_dwordx2 v8, v[138:139], s[38:39] offset:0 sc1
    v_cvt_pk_bf16_f32 v140, v108, v109
    v_cvt_pk_bf16_f32 v141, v110, v111
    v_and_or_b32 v140, v140, v12, v13
    v_and_or_b32 v141, v141, v12, v14
    global_store_dwordx2 v9, v[140:141], s[38:39] offset:0 sc1
    v_cvt_pk_bf16_f32 v142, v112, v113
    v_cvt_pk_bf16_f32 v143, v114, v115
    v_and_or_b32 v142, v142, v12, v13
    v_and_or_b32 v143, v143, v12, v14
    global_store_dwordx2 v8, v[142:143], s[38:39] offset:512 sc1
    v_cvt_pk_bf16_f32 v144, v116, v117
    v_cvt_pk_bf16_f32 v145, v118, v119
    v_and_or_b32 v144, v144, v12, v13
    v_and_or_b32 v145, v145, v12, v14
    global_store_dwordx2 v9, v[144:145], s[38:39] offset:512 sc1
    s_cmp_ge_u32 s3, 4
    s_cbranch_scc1 La1s7
    v_cvt_pk_bf16_f32 v146, v120, v121
    v_cvt_pk_bf16_f32 v147, v122, v123
    v_and_or_b32 v146, v146, v12, v13
    v_and_or_b32 v147, v147, v12, v14
    global_store_dwordx2 v8, v[146:147], s[38:39] offset:1024 sc1
    v_cvt_pk_bf16_f32 v148, v124, v125
    v_cvt_pk_bf16_f32 v149, v126, v127
    v_and_or_b32 v148, v148, v12, v13
    v_and_or_b32 v149, v149, v12, v14
    global_store_dwordx2 v9, v[148:149], s[38:39] offset:1024 sc1
    s_branch La1s6
La1s7:
    s_cmp_ge_u32 s3, 6
    s_cbranch_scc1 La1s6
    v_cvt_pk_bf16_f32 v146, v120, v121
    v_cvt_pk_bf16_f32 v147, v124, v125
    v_and_b32 v1, 63, v10
    s_mov_b32 exec_lo, 65537
    s_mov_b32 exec_hi, 65537
    ds_write_b32 v1, v146 offset:160
    ds_write_b32 v1, v147 offset:192
    s_mov_b64 exec, -1
    v_mov_b32 v1, 124
    v_mov_b32 v2, 1
    s_waitcnt lgkmcnt(0)
    s_mov_b64 exec, 1
    ds_add_u32 v1, v2
    s_mov_b64 exec, -1
La1s6:
    s_setprio 0
    s_cmp_lt_u32 s7, 33
    s_cbranch_scc1 La18
    s_nop 1
    s_mov_b32 s52, 147456
    v_and_b32 v132, 15, v0
    v_lshrrev_b32 v133, 4, v0
    s_sub_u32 s12, s3, 0
    s_nop 0
Lc9:
    s_cmp_ge_u32 s12, 5
    s_cselect_b32 s13, 1, 0
    s_sub_u32 s8, s12, 10
    s_cmp_ge_u32 s12, 10
    s_cselect_b32 s13, s8, s13
    s_cmp_eq_u32 s13, 2
    s_cselect_b32 s14, 20, 10
    s_mov_b32 s15, 117834241
    s_cselect_b32 s15, 252314880, s15
    s_and_b32 s8, s13, 1
    s_mul_i32 s8, s8, 40
    v_mul_lo_u32 v134, v133, s14
    v_add_u32 v134, s8, v134
    s_bfe_u32 s8, s15, 524288
    v_add_u32 v136, s8, v134
    s_bfe_u32 s8, s15, 524296
    v_add_u32 v137, s8, v134
    s_bfe_u32 s8, s15, 524304
    v_add_u32 v138, s8, v134
    s_bfe_u32 s8, s15, 524312
    v_add_u32 v139, s8, v134
    s_cmp_ge_u32 s12, 10
    s_cbranch_scc1 Lc10
    s_mul_i32 s8, s13, 5
    s_sub_u32 s8, s12, s8
    s_lshl_b32 s8, s8, 4
    v_add_u32 v134, s8, v132
    v_mul_u32_u24 v136, v134, v136
    v_cvt_f32_u32 v136, v136
    v_mul_f32 v136, 0x3c4ccccd, v136
    v_mul_u32_u24 v137, v134, v137
    v_cvt_f32_u32 v137, v137
    v_mul_f32 v137, 0x3c4ccccd, v137
    v_mul_u32_u24 v138, v134, v138
    v_cvt_f32_u32 v138, v138
    v_mul_f32 v138, 0x3c4ccccd, v138
    v_mul_u32_u24 v139, v134, v139
    v_cvt_f32_u32 v139, v139
    v_mul_f32 v139, 0x3c4ccccd, v139
    v_cos_f32 v140, v136
    v_sin_f32 v144, v136
    v_cos_f32 v141, v137
    v_sin_f32 v145, v137
    v_cos_f32 v142, v138
    v_sin_f32 v146, v138
    v_cos_f32 v143, v139
    v_sin_f32 v147, v139
    v_cvt_pk_bf16_f32 v148, v140, v141
    v_cvt_pk_bf16_f32 v150, -v144, -v145
    v_cvt_pk_bf16_f32 v149, v142, v143
    v_cvt_pk_bf16_f32 v151, -v146, -v147
    s_lshl_b32 s8, s12, 10
    s_add_u32 s8, s8, s52
    v_lshl_add_u32 v135, v0, 4, s8
    ds_write_b128 v135, v[148:151]
    s_branch Lc11
Lc10:
    v_and_b32 v134, 7, v0
    v_mul_u32_u24 v136, v134, v136
    v_cvt_f32_u32 v136, v136
    v_mul_f32 v136, 0x3acccccd, v136
    v_mul_u32_u24 v137, v134, v137
    v_cvt_f32_u32 v137, v137
    v_mul_f32 v137, 0x3acccccd, v137
    v_mul_u32_u24 v138, v134, v138
    v_cvt_f32_u32 v138, v138
    v_mul_f32 v138, 0x3acccccd, v138
    v_mul_u32_u24 v139, v134, v139
    v_cvt_f32_u32 v139, v139
    v_mul_f32 v139, 0x3acccccd, v139
    v_cos_f32 v140, v136
    v_sin_f32 v144, v136
    v_cos_f32 v141, v137
    v_sin_f32 v145, v137
    v_cos_f32 v142, v138
    v_sin_f32 v146, v138
    v_cos_f32 v143, v139
    v_sin_f32 v147, v139
    s_lshl_b32 s8, s13, 11
    s_add_u32 s8, s8, 10240
    s_add_u32 s8, s8, s52
    v_lshl_add_u32 v135, v0, 4, s8
    ds_write_b128 v135, v[140:143]
    ds_write_b128 v135, v[144:147] offset:1024
Lc11:
    s_add_u32 s12, s12, 8
    s_cmp_lt_u32 s12, 13
    s_cbranch_scc1 Lc9
La18:
    v_mov_b32 v1, 4
    v_mov_b32 v2, 1
    s_waitcnt vmcnt(0) lgkmcnt(0)
    s_mov_b64 exec, 1
    ds_add_u32 v1, v2
    s_mov_b64 exec, -1
    s_cmp_ge_u32 s7, 33
    s_cbranch_scc1 LB2
    s_cmp_ge_u32 s3, 4
    s_cbranch_scc1 LB2
    s_add_u32 s9, s6, 16
    s_mov_b32 s10, s3
    s_mov_b32 s62, 111360
    s_mov_b32 s63, 127744
    s_mov_b32 s61, 56
    s_mov_b32 s60, 72
    s_branch LA2
LauxE:
    s_sub_u32 s10, s3, 8
    s_mov_b32 s9, s6
    s_mov_b32 s62, 94976
    s_mov_b32 s63, 62208
    s_mov_b32 s61, 40
    s_mov_b32 s60, 8
    s_and_b32 s15, s10, 1
    v_lshlrev_b32 v132, 4, v0
    s_lshl_b32 s8, s10, 10
    v_add_u32 v133, s8, v132
    v_subrev_u32 v134, 128, v132
    v_subrev_u32 v135, 112, v132
    s_add_u32 s8, s53, 0
    s_lshl_b32 s8, s8, 12
    s_add_u32 s44, s30, s8
    s_addc_u32 s45, s31, 0
    s_and_b32 s45, s45, 65535
    s_mov_b32 s46, 4096
    s_mov_b32 s47, 131072
    buffer_load_dwordx4 v[136:139], v133, s[44:47], 0 offen
    buffer_load_dwordx2 v[140:141], v133, s[44:47], 0 offen offset:16
    s_add_u32 s8, s53, 1
    s_lshl_b32 s8, s8, 12
    s_add_u32 s44, s30, s8
    s_addc_u32 s45, s31, 0
    s_and_b32 s45, s45, 65535
    s_mov_b32 s46, 4096
    s_mov_b32 s47, 131072
    buffer_load_dwordx4 v[142:145], v133, s[44:47], 0 offen
    buffer_load_dwordx2 v[146:147], v133, s[44:47], 0 offen offset:16
    s_add_u32 s8, s53, s15
    s_lshl_b32 s8, s8, 12
    s_add_u32 s44, s30, s8
    s_addc_u32 s45, s31, 0
    s_and_b32 s45, s45, 65535
    s_mov_b32 s46, 4096
    s_mov_b32 s47, 131072
    buffer_load_dwordx4 v[148:151], v134, s[44:47], 0 offen offset:0
    buffer_load_dwordx2 v[152:153], v135, s[44:47], 0 offen offset:0
    s_cmp_lg_u32 s3, 11
    s_cbranch_scc1 La112
    v_and_b32 v1, 15, v0
    v_lshl_add_u32 v1, s7, 4, v1
    v_mul_u32_u24 v1, 642, v1
    global_load_ushort v112, v1, s[18:19] offset:640
    global_load_ushort v113, v1, s[20:21] offset:640
La112:
    v_mov_b32 v100, 0
    v_mov_b32 v101, 0
    v_mov_b32 v102, 0
    v_mov_b32 v103, 0
    s_mul_i32 s8, s15, 30976
    s_add_u32 s8, s8, 21776
    v_lshl_add_u32 v1, v0, 4, s8
    ds_write_b128 v1, v[100:103]
    s_mov_b64 exec, 255
    ds_write_b128 v1, v[100:103] offset:1024
    s_mov_b64 exec, -1
    v_add_u32 v133, 256, v133
    s_mul_i32 s8, s15, 30976
    s_add_u32 s8, s8, 256
    v_add_u32 v134, s8, v132
    s_nop 1
LA2:
    s_cmp_ge_u32 s9, 10
    s_cselect_b32 s11, 8, 0
    s_cselect_b32 s12, 10, 0
    s_add_u32 s11, s11, s4
    s_sub_u32 s12, s9, s12
    s_mul_i32 s13, s11, 10
    s_add_u32 s13, s13, s12
    s_cmp_eq_u32 s9, 20
    s_cselect_b32 s13, 160, s13
    s_mul_i32 s14, s12, 6560
    s_lshr_b32 s14, s14, 12
    s_mul_i32 s14, s14, 20
    v_lshrrev_b32 v1, 3, v0
    v_and_b32 v2, 7, v0
    v_mul_u32_u24 v155, 10272, v1
    v_lshl_add_u32 v155, v2, 4, v155
    s_lshl_b32 s8, s10, 9
    s_add_u32 s8, s8, s11
    s_mul_i32 s8, s8, 642
    s_lshl1_add_u32 s8, s14, s8
    s_bfe_u32 s15, s8, 65537
    s_and_b32 s8, s8, -4
    v_add_u32 v155, s8, v155
    v_and_b32 v7, 15, v0
    v_lshrrev_b32 v6, 4, v0
    v_lshrrev_b32 v1, 3, v0
    v_lshl_add_u32 v1, s10, 3, v1
    v_mul_u32_u24 v3, 20608, v1
    v_and_b32 v2, 7, v0
    v_lshl_add_u32 v3, v2, 4, v3
    s_lshl_b32 s8, s13, 7
    v_add_u32 v3, s8, v3
    v_xor_b32 v4, v1, v2
    v_and_b32 v4, 7, v4
    v_lshlrev_b32 v4, 4, v4
    v_lshl_add_u32 v4, v1, 7, v4
    v_add_u32 v4, s62, v4
    s_lshl_b32 s8, s10, 1
    v_xor_b32 v5, s8, v2
    v_lshlrev_b32 v5, 4, v5
    v_lshl_add_u32 v1, v6, 5, v2
    v_lshl_add_u32 v5, v1, 7, v5
    v_bfe_u32 v1, v0, 3, 1
    v_lshl_add_u32 v5, v1, 2, v5
    v_add_u32 v5, s62, v5
    v_xor_b32 v154, 16, v5
    v_lshrrev_b32 v1, 3, v0
    v_lshlrev_b32 v2, 1, v2
    v_xor_b32 v2, v1, v2
    v_lshlrev_b32 v1, 8, v1
    v_lshl_add_u32 v156, v2, 4, v1
    s_lshl_b32 s8, s10, 13
    s_add_u32 s8, s8, s63
    v_add_u32 v156, s8, v156
    v_xor_b32 v157, 16, v156
    v_and_b32 v1, 1, v6
    v_lshlrev_b32 v49, 14, v1
    v_add_u32 v49, s63, v49
    s_lshl_b32 s8, s12, 5
    s_lshl2_add_u32 s8, s10, s8
    s_sub_u32 s8, s8, s14
    v_lshrrev_b32 v1, 5, v0
    v_lshl_add_u32 v44, v1, 4, s8
    s_cmp_eq_u32 s9, 20
    s_cbranch_scc1 La213
    v_lshl_add_u32 v49, v7, 8, v49
    v_and_b32 v50, 7, v0
    v_mul_u32_u24 v45, 13, v44
    v_lshrrev_b32 v45, 8, v45
    v_mul_u32_u24 v45, 20, v45
    v_sub_u32 v46, v44, v45
    v_lshrrev_b32 v47, 1, v46
    v_mul_u32_u24 v47, 5, v47
    v_and_b32 v2, 1, v46
    v_add_u32 v47, v47, v2
    v_add_u32 v48, 1, v47
    v_sub_u32 v47, 39, v47
    v_cmp_gt_u32 vcc, 8, v46
    s_nop 1
    v_cndmask_b32 v48, v47, v48, vcc
    v_mul_u32_u24 v47, 5, v46
    v_subrev_u32 v47, 80, v47
    v_cmp_gt_u32 vcc, 16, v46
    s_nop 1
    v_cndmask_b32 v48, v47, v48, vcc
    v_add3_u32 v48, v48, v45, s15
    v_lshrrev_b32 v47, 2, v48
    v_xor_b32 v47, v47, v50
    v_lshl_add_u32 v8, v47, 4, v49
    v_and_b32 v48, 3, v48
    v_lshl_add_u32 v8, v48, 2, v8
    v_add_u32 v44, 1, v44
    v_mul_u32_u24 v45, 13, v44
    v_lshrrev_b32 v45, 8, v45
    v_mul_u32_u24 v45, 20, v45
    v_sub_u32 v46, v44, v45
    v_lshrrev_b32 v47, 1, v46
    v_mul_u32_u24 v47, 5, v47
    v_and_b32 v2, 1, v46
    v_add_u32 v47, v47, v2
    v_add_u32 v48, 1, v47
    v_sub_u32 v47, 39, v47
    v_cmp_gt_u32 vcc, 8, v46
    s_nop 1
    v_cndmask_b32 v48, v47, v48, vcc
    v_mul_u32_u24 v47, 5, v46
    v_subrev_u32 v47, 80, v47
    v_cmp_gt_u32 vcc, 16, v46
    s_nop 1
    v_cndmask_b32 v48, v47, v48, vcc
    v_add3_u32 v48, v48, v45, s15
    v_lshrrev_b32 v47, 2, v48
    v_xor_b32 v47, v47, v50
    v_lshl_add_u32 v9, v47, 4, v49
    v_and_b32 v48, 3, v48
    v_lshl_add_u32 v9, v48, 2, v9
    v_add_u32 v44, 1, v44
    v_mul_u32_u24 v45, 13, v44
    v_lshrrev_b32 v45, 8, v45
    v_mul_u32_u24 v45, 20, v45
    v_sub_u32 v46, v44, v45
    v_lshrrev_b32 v47, 1, v46
    v_mul_u32_u24 v47, 5, v47
    v_and_b32 v2, 1, v46
    v_add_u32 v47, v47, v2
    v_add_u32 v48, 1, v47
    v_sub_u32 v47, 39, v47
    v_cmp_gt_u32 vcc, 8, v46
    s_nop 1
    v_cndmask_b32 v48, v47, v48, vcc
    v_mul_u32_u24 v47, 5, v46
    v_subrev_u32 v47, 80, v47
    v_cmp_gt_u32 vcc, 16, v46
    s_nop 1
    v_cndmask_b32 v48, v47, v48, vcc
    v_add3_u32 v48, v48, v45, s15
    v_lshrrev_b32 v47, 2, v48
    v_xor_b32 v47, v47, v50
    v_lshl_add_u32 v10, v47, 4, v49
    v_and_b32 v48, 3, v48
    v_lshl_add_u32 v10, v48, 2, v10
    v_add_u32 v44, 1, v44
    v_mul_u32_u24 v45, 13, v44
    v_lshrrev_b32 v45, 8, v45
    v_mul_u32_u24 v45, 20, v45
    v_sub_u32 v46, v44, v45
    v_lshrrev_b32 v47, 1, v46
    v_mul_u32_u24 v47, 5, v47
    v_and_b32 v2, 1, v46
    v_add_u32 v47, v47, v2
    v_add_u32 v48, 1, v47
    v_sub_u32 v47, 39, v47
    v_cmp_gt_u32 vcc, 8, v46
    s_nop 1
    v_cndmask_b32 v48, v47, v48, vcc
    v_mul_u32_u24 v47, 5, v46
    v_subrev_u32 v47, 80, v47
    v_cmp_gt_u32 vcc, 16, v46
    s_nop 1
    v_cndmask_b32 v48, v47, v48, vcc
    v_add3_u32 v48, v48, v45, s15
    v_lshrrev_b32 v47, 2, v48
    v_xor_b32 v47, v47, v50
    v_lshl_add_u32 v11, v47, 4, v49
    v_and_b32 v48, 3, v48
    v_lshl_add_u32 v11, v48, 2, v11
    s_nop 0
    s_branch La214
La213:
    v_and_b32 v2, 1, v6
    v_lshl_add_u32 v2, v2, 6, v7
    v_lshlrev_b32 v49, 7, v2
    v_lshl_add_u32 v49, v1, 2, v49
    v_add_u32 v49, s62, v49
    s_and_b32 s8, s10, 1
    s_lshl_b32 s8, s8, 1
    s_add_u32 s8, s8, 4
    v_xor_b32 v2, s8, v7
    v_and_b32 v2, 7, v2
    v_lshl_add_u32 v8, v2, 4, v49
    v_xor_b32 v10, 16, v8
    s_nop 1
La214:
    v_cvt_f32_u32 v84, v7
    v_lshlrev_b32 v85, 2, v6
    v_cvt_f32_u32 v85, v85
    v_mul_f32 v86, 0x3d800000, v84
    v_mul_f32 v88, v86, v85
    v_add_f32 v89, v88, v86
    v_add_f32 v90, v89, v86
    v_add_f32 v91, v90, v86
    v_cos_f32 v92, v88
    v_sin_f32 v96, v88
    v_cos_f32 v93, v89
    v_sin_f32 v97, v89
    v_cos_f32 v94, v90
    v_sin_f32 v98, v90
    v_cos_f32 v95, v91
    v_sin_f32 v99, v91
    v_cvt_pk_bf16_f32 v12, v92, v96
    v_cvt_pk_bf16_f32 v16, -v96, v92
    v_cvt_pk_bf16_f32 v13, v93, v97
    v_cvt_pk_bf16_f32 v17, -v97, v93
    v_cvt_pk_bf16_f32 v14, v94, v98
    v_cvt_pk_bf16_f32 v18, -v98, v94
    v_cvt_pk_bf16_f32 v15, v95, v99
    v_cvt_pk_bf16_f32 v19, -v99, v95
    v_and_b32 v2, 7, v0
    v_cvt_f32_u32 v2, v2
    v_mul_f32 v86, 0x3c000000, v2
    v_mul_f32 v88, v86, v85
    v_add_f32 v89, v88, v86
    v_add_f32 v90, v89, v86
    v_add_f32 v91, v90, v86
    v_cos_f32 v36, v88
    v_sin_f32 v40, v88
    v_cos_f32 v37, v89
    v_sin_f32 v41, v89
    v_cos_f32 v38, v90
    v_sin_f32 v42, v90
    v_cos_f32 v39, v91
    v_sin_f32 v43, v91
    v_and_b32 v85, 1, v6
    v_lshlrev_b32 v85, 2, v85
    v_cvt_f32_u32 v85, v85
    v_mul_f32 v86, 0x3c000000, v84
    v_mul_f32 v88, v86, v85
    v_add_f32 v89, v88, v86
    v_add_f32 v90, v89, v86
    v_add_f32 v91, v90, v86
    v_cos_f32 v28, v88
    v_sin_f32 v32, v88
    v_cos_f32 v29, v89
    v_sin_f32 v33, v89
    v_cos_f32 v30, v90
    v_sin_f32 v34, v90
    v_cos_f32 v31, v91
    v_sin_f32 v35, v91
    v_mul_f32 v86, 0x3e000000, v2
    v_mul_f32 v88, v86, v85
    v_add_f32 v89, v88, v86
    v_add_f32 v90, v89, v86
    v_add_f32 v91, v90, v86
    v_cos_f32 v92, v88
    v_sin_f32 v96, v88
    v_cos_f32 v93, v89
    v_sin_f32 v97, v89
    v_cos_f32 v94, v90
    v_sin_f32 v98, v90
    v_cos_f32 v95, v91
    v_sin_f32 v99, v91
    v_bfe_u32 v1, v0, 3, 1
    v_lshrrev_b32 v2, 5, v0
    v_cmp_eq_u32 vcc, v1, v2
    s_nop 1
    v_cndmask_b32 v2, 0, -1, vcc
    v_cvt_pk_bf16_f32 v20, v92, v96
    v_cvt_pk_bf16_f32 v24, -v96, v92
    v_and_b32 v20, v2, v20
    v_and_b32 v24, v2, v24
    v_cvt_pk_bf16_f32 v21, v93, v97
    v_cvt_pk_bf16_f32 v25, -v97, v93
    v_and_b32 v21, v2, v21
    v_and_b32 v25, v2, v25
    v_cvt_pk_bf16_f32 v22, v94, v98
    v_cvt_pk_bf16_f32 v26, -v98, v94
    v_and_b32 v22, v2, v22
    v_and_b32 v26, v2, v26
    v_cvt_pk_bf16_f32 v23, v95, v99
    v_cvt_pk_bf16_f32 v27, -v99, v95
    v_and_b32 v23, v2, v23
    v_and_b32 v27, v2, v27
    s_mov_b32 s12, s18
    s_and_b32 s13, s19, 65535
    s_mov_b32 s14, 1314816
    s_mov_b32 s15, 131072
    s_mov_b32 s56, s20
    s_and_b32 s57, s21, 65535
    s_mov_b32 s58, 1314816
    s_mov_b32 s59, 131072
    s_cmp_lt_u32 s3, 8
    s_cbranch_scc1 La215
    s_waitcnt vmcnt(0)
    v_alignbit_b32 v100, v137, v136, 16
    v_alignbit_b32 v101, v138, v137, 16
    v_alignbit_b32 v102, v139, v138, 16
    v_alignbit_b32 v103, v140, v139, 16
    ds_write_b128 v133, v[100:103] offset:128
    v_alignbit_b32 v104, v138, v137, 16
    v_alignbit_b32 v105, v139, v138, 16
    v_alignbit_b32 v106, v140, v139, 16
    v_alignbit_b32 v107, v141, v140, 16
    ds_write_b128 v133, v[104:107] offset:4352
    ds_write_b128 v133, v[138:141] offset:12816
    v_mov_b32 v108, v137
    v_mov_b32 v109, v138
    v_mov_b32 v110, v139
    v_mov_b32 v111, v140
    ds_write_b128 v133, v[108:111] offset:8592
    v_alignbit_b32 v100, v143, v142, 16
    v_alignbit_b32 v101, v144, v143, 16
    v_alignbit_b32 v102, v145, v144, 16
    v_alignbit_b32 v103, v146, v145, 16
    ds_write_b128 v133, v[100:103] offset:31104
    v_alignbit_b32 v104, v144, v143, 16
    v_alignbit_b32 v105, v145, v144, 16
    v_alignbit_b32 v106, v146, v145, 16
    v_alignbit_b32 v107, v147, v146, 16
    ds_write_b128 v133, v[104:107] offset:35328
    ds_write_b128 v133, v[144:147] offset:43792
    v_mov_b32 v108, v143
    v_mov_b32 v109, v144
    v_mov_b32 v110, v145
    v_mov_b32 v111, v146
    ds_write_b128 v133, v[108:111] offset:39568
    s_mov_b64 exec, 255
    v_alignbit_b32 v100, v149, v148, 16
    v_alignbit_b32 v101, v150, v149, 16
    v_alignbit_b32 v102, v151, v150, 16
    v_alignbit_b32 v103, v152, v151, 16
    ds_write_b128 v134, v[100:103] offset:0
    v_alignbit_b32 v104, v150, v149, 16
    v_alignbit_b32 v105, v151, v150, 16
    v_alignbit_b32 v106, v152, v151, 16
    v_alignbit_b32 v107, v153, v152, 16
    ds_write_b128 v134, v[104:107] offset:4224
    ds_write_b128 v134, v[150:153] offset:12688
    v_mov_b32 v108, v149
    v_mov_b32 v109, v150
    v_mov_b32 v110, v151
    v_mov_b32 v111, v152
    ds_write_b128 v134, v[108:111] offset:8464
    s_mov_b64 exec, -1
    v_mov_b32 v1, 28
    v_mov_b32 v2, 1
    s_waitcnt lgkmcnt(0)
    s_mov_b64 exec, 1
    ds_add_u32 v1, v2
    s_mov_b64 exec, -1
    s_cmp_lg_u32 s3, 11
    s_cbranch_scc1 La215
    v_mov_b32 v1, 124
    s_nop 1
Lbl16:
    ds_read_b32 v2, v1
    s_waitcnt lgkmcnt(0)
    v_readfirstlane_b32 s40, v2
    s_cmp_lt_u32 s40, 2
    s_cbranch_scc1 Lbl16
Lbd17:
    v_lshlrev_b32 v1, 2, v0
    ds_read_b32 v114, v1 offset:160
    v_lshl_or_b32 v112, v113, 16, v112
    v_cmp_gt_u32 vcc, 16, v0
    s_waitcnt lgkmcnt(0)
    s_nop 0
    v_cndmask_b32 v112, v112, v114, vcc
    v_and_b32 v2, 2, v0
    v_lshlrev_b32 v2, 15, v2
    v_and_or_b32 v2, v0, 1, v2
    v_and_b32 v112, 4294901758, v112
    v_or_b32 v112, v112, v2
    s_mul_i32 s8, s7, 20608
    s_add_u32 s8, s8, 20480
    v_add_u32 v1, s8, v1
    s_mov_b32 exec_hi, 0
    global_store_dword v1, v112, s[38:39] sc1
    s_mov_b64 exec, -1
La215:
    s_add_u32 s44, s38, 0
    s_addc_u32 s45, s39, 0
    s_add_u32 s46, s38, 659456
    s_addc_u32 s47, s39, 0
    s_add_u32 s48, s38, 1318912
    s_addc_u32 s49, s39, 0
    s_add_u32 s50, s38, 1978368
    s_addc_u32 s51, s39, 0
    v_mov_b32 v158, 84148480
    v_mov_b32 v160, 117834498
    v_mov_b32 v161, 4294901760
    v_mov_b32 v1, 4
    s_nop 1
Lw18:
    s_sleep 1
    ds_read_b32 v2, v1
    s_waitcnt lgkmcnt(0)
    v_readfirstlane_b32 s40, v2
    s_cmp_lt_u32 s40, 8
    s_cbranch_scc1 Lw18
    s_setprio 3
    s_mov_b32 s41, 32768
Lg19:
    global_load_dwordx4 v[100:103], v3, s[44:45] sc1
    global_load_dwordx4 v[104:107], v3, s[46:47] sc1
    global_load_dwordx4 v[108:111], v3, s[48:49] sc1
    s_waitcnt vmcnt(3)
    global_load_dwordx4 v[112:115], v3, s[50:51] sc1
    s_sub_u32 s41, s41, 1
    s_waitcnt vmcnt(3)
    v_bitop3_b32 v1, v103, v100, v100 bitop3:0xcf
    v_bitop3_b32 v1, v1, v101, 1 bitop3:0xf6
    v_bitop3_b32 v1, v1, v102, s101 bitop3:0xf6
    s_waitcnt vmcnt(2)
    v_bitop3_b32 v1, v1, v107, v104 bitop3:0xfb
    v_bitop3_b32 v1, v1, v105, 1 bitop3:0xf6
    v_bitop3_b32 v1, v1, v106, s101 bitop3:0xf6
    s_waitcnt vmcnt(1)
    v_bitop3_b32 v1, v1, v111, v108 bitop3:0xfb
    v_bitop3_b32 v1, v1, v109, 1 bitop3:0xf6
    v_bitop3_b32 v1, v1, v110, s101 bitop3:0xf6
    s_waitcnt vmcnt(0)
    v_bitop3_b32 v1, v1, v115, v112 bitop3:0xfb
    v_bitop3_b32 v1, v1, v113, 1 bitop3:0xf6
    v_bitop3_b32 v1, v1, v114, s101 bitop3:0xf6
    v_and_b32 v1, 65537, v1
    v_cmp_ne_u32 vcc, 0, v1
    s_nop 3
    s_cbranch_scc1 Lg20
    s_cbranch_vccz Lg20
    s_sleep 8
    s_branch Lg19
Lg20:
    ds_write_b128 v4, v[100:103] offset:0
    ds_write_b128 v4, v[104:107] offset:4096
    ds_write_b128 v4, v[108:111] offset:8192
    ds_write_b128 v4, v[112:115] offset:12288
    v_mov_b32 v1, s61
    v_mov_b32 v2, 1
    s_waitcnt lgkmcnt(0)
    s_mov_b64 exec, 1
    ds_add_u32 v1, v2
    s_mov_b64 exec, -1
La221:
    ds_read_b32 v2, v1
    s_waitcnt lgkmcnt(0)
    v_readfirstlane_b32 s40, v2
    s_cmp_lt_u32 s40, 4
    s_cbranch_scc1 La221
    ds_read_b32 v84, v5 offset:0
    ds_read_b32 v85, v5 offset:1024
    ds_read_b32 v86, v5 offset:2048
    ds_read_b32 v87, v5 offset:3072
    ds_read_b32 v88, v5 offset:8
    ds_read_b32 v89, v5 offset:1032
    ds_read_b32 v90, v5 offset:2056
    ds_read_b32 v91, v5 offset:3080
    ds_read_b32 v92, v154 offset:0
    ds_read_b32 v93, v154 offset:1024
    ds_read_b32 v94, v154 offset:2048
    ds_read_b32 v95, v154 offset:3072
    ds_read_b32 v96, v154 offset:8
    ds_read_b32 v97, v154 offset:1032
    ds_read_b32 v98, v154 offset:2056
    ds_read_b32 v99, v154 offset:3080
    s_waitcnt lgkmcnt(12)
    v_mfma_f32_16x16x32_bf16 v[100:103], v[84:87], v[12:15], 0
    v_mfma_f32_16x16x32_bf16 v[104:107], v[84:87], v[16:19], 0
    s_waitcnt lgkmcnt(8)
    v_mfma_f32_16x16x32_bf16 v[108:111], v[88:91], v[12:15], 0
    v_mfma_f32_16x16x32_bf16 v[112:115], v[88:91], v[16:19], 0
    s_waitcnt lgkmcnt(4)
    v_mfma_f32_16x16x32_bf16 v[116:119], v[92:95], v[12:15], 0
    v_mfma_f32_16x16x32_bf16 v[120:123], v[92:95], v[16:19], 0
    s_waitcnt lgkmcnt(0)
    v_mfma_f32_16x16x32_bf16 v[124:127], v[96:99], v[12:15], 0
    v_mfma_f32_16x16x32_bf16 v[128:131], v[96:99], v[16:19], 0
    s_cmp_eq_u32 s9, 20
    s_nop 5
    s_cbranch_scc1 La222
    s_mov_b32 s8, 0
    buffer_load_dwordx4 v[52:55], v155, s[12:15], s8 offen
    buffer_load_dwordx4 v[68:71], v155, s[56:59], s8 offen
    s_mov_b32 s8, 82176
    buffer_load_dwordx4 v[56:59], v155, s[12:15], s8 offen
    buffer_load_dwordx4 v[72:75], v155, s[56:59], s8 offen
    s_mov_b32 s8, 164352
    buffer_load_dwordx4 v[60:63], v155, s[12:15], s8 offen
    buffer_load_dwordx4 v[76:79], v155, s[56:59], s8 offen
    s_mov_b32 s8, 246528
    buffer_load_dwordx4 v[64:67], v155, s[12:15], s8 offen
    buffer_load_dwordx4 v[80:83], v155, s[56:59], s8 offen
La222:
    v_mul_f32 v44, v100, v28
    v_mul_f32 v45, v104, v28
    v_fmac_f32 v44, v104, v32
    v_fma_f32 v45, -v100, v32, v45
    v_cvt_pk_bf16_f32 v84, v44, v45
    v_mul_f32 v46, v101, v29
    v_mul_f32 v47, v105, v29
    v_fmac_f32 v46, v105, v33
    v_fma_f32 v47, -v101, v33, v47
    v_cvt_pk_bf16_f32 v85, v46, v47
    v_mul_f32 v44, v102, v30
    v_mul_f32 v45, v106, v30
    v_fmac_f32 v44, v106, v34
    v_fma_f32 v45, -v102, v34, v45
    v_cvt_pk_bf16_f32 v86, v44, v45
    v_mul_f32 v46, v103, v31
    v_mul_f32 v47, v107, v31
    v_fmac_f32 v46, v107, v35
    v_fma_f32 v47, -v103, v35, v47
    v_cvt_pk_bf16_f32 v87, v46, v47
    s_nop 1
    v_mfma_f32_16x16x32_bf16 v[100:103], v[20:23], v[84:87], 0
    v_mfma_f32_16x16x32_bf16 v[104:107], v[24:27], v[84:87], 0
    v_mul_f32 v44, v108, v28
    v_mul_f32 v45, v112, v28
    v_fmac_f32 v44, v112, v32
    v_fma_f32 v45, -v108, v32, v45
    v_cvt_pk_bf16_f32 v88, v44, v45
    v_mul_f32 v46, v109, v29
    v_mul_f32 v47, v113, v29
    v_fmac_f32 v46, v113, v33
    v_fma_f32 v47, -v109, v33, v47
    v_cvt_pk_bf16_f32 v89, v46, v47
    v_mul_f32 v44, v110, v30
    v_mul_f32 v45, v114, v30
    v_fmac_f32 v44, v114, v34
    v_fma_f32 v45, -v110, v34, v45
    v_cvt_pk_bf16_f32 v90, v44, v45
    v_mul_f32 v46, v111, v31
    v_mul_f32 v47, v115, v31
    v_fmac_f32 v46, v115, v35
    v_fma_f32 v47, -v111, v35, v47
    v_cvt_pk_bf16_f32 v91, v46, v47
    s_nop 1
    v_mfma_f32_16x16x32_bf16 v[108:111], v[20:23], v[88:91], 0
    v_mfma_f32_16x16x32_bf16 v[112:115], v[24:27], v[88:91], 0
    v_mul_f32 v44, v116, v28
    v_mul_f32 v45, v120, v28
    v_fmac_f32 v44, v120, v32
    v_fma_f32 v45, -v116, v32, v45
    v_cvt_pk_bf16_f32 v92, v44, v45
    v_mul_f32 v46, v117, v29
    v_mul_f32 v47, v121, v29
    v_fmac_f32 v46, v121, v33
    v_fma_f32 v47, -v117, v33, v47
    v_cvt_pk_bf16_f32 v93, v46, v47
    v_mul_f32 v44, v118, v30
    v_mul_f32 v45, v122, v30
    v_fmac_f32 v44, v122, v34
    v_fma_f32 v45, -v118, v34, v45
    v_cvt_pk_bf16_f32 v94, v44, v45
    v_mul_f32 v46, v119, v31
    v_mul_f32 v47, v123, v31
    v_fmac_f32 v46, v123, v35
    v_fma_f32 v47, -v119, v35, v47
    v_cvt_pk_bf16_f32 v95, v46, v47
    s_nop 1
    v_mfma_f32_16x16x32_bf16 v[116:119], v[20:23], v[92:95], 0
    v_mfma_f32_16x16x32_bf16 v[120:123], v[24:27], v[92:95], 0
    v_mul_f32 v44, v124, v28
    v_mul_f32 v45, v128, v28
    v_fmac_f32 v44, v128, v32
    v_fma_f32 v45, -v124, v32, v45
    v_cvt_pk_bf16_f32 v96, v44, v45
    v_mul_f32 v46, v125, v29
    v_mul_f32 v47, v129, v29
    v_fmac_f32 v46, v129, v33
    v_fma_f32 v47, -v125, v33, v47
    v_cvt_pk_bf16_f32 v97, v46, v47
    v_mul_f32 v44, v126, v30
    v_mul_f32 v45, v130, v30
    v_fmac_f32 v44, v130, v34
    v_fma_f32 v45, -v126, v34, v45
    v_cvt_pk_bf16_f32 v98, v44, v45
    v_mul_f32 v46, v127, v31
    v_mul_f32 v47, v131, v31
    v_fmac_f32 v46, v131, v35
    v_fma_f32 v47, -v127, v35, v47
    v_cvt_pk_bf16_f32 v99, v46, v47
    s_nop 1
    v_mfma_f32_16x16x32_bf16 v[124:127], v[20:23], v[96:99], 0
    v_mfma_f32_16x16x32_bf16 v[128:131], v[24:27], v[96:99], 0
    s_cmp_eq_u32 s9, 20
    s_nop 5
    s_cbranch_scc1 La224
    s_waitcnt vmcnt(0)
    v_perm_b32 v44, v68, v52, v158
    v_perm_b32 v45, v68, v52, v160
    v_perm_b32 v46, v69, v53, v158
    v_perm_b32 v47, v69, v53, v160
    ds_write_b128 v156, v[44:47] offset:0
    v_perm_b32 v48, v70, v54, v158
    v_perm_b32 v49, v70, v54, v160
    v_perm_b32 v50, v71, v55, v158
    v_perm_b32 v51, v71, v55, v160
    ds_write_b128 v157, v[48:51] offset:0
    v_perm_b32 v44, v72, v56, v158
    v_perm_b32 v45, v72, v56, v160
    v_perm_b32 v46, v73, v57, v158
    v_perm_b32 v47, v73, v57, v160
    ds_write_b128 v156, v[44:47] offset:2048
    v_perm_b32 v48, v74, v58, v158
    v_perm_b32 v49, v74, v58, v160
    v_perm_b32 v50, v75, v59, v158
    v_perm_b32 v51, v75, v59, v160
    ds_write_b128 v157, v[48:51] offset:2048
    v_perm_b32 v44, v76, v60, v158
    v_perm_b32 v45, v76, v60, v160
    v_perm_b32 v46, v77, v61, v158
    v_perm_b32 v47, v77, v61, v160
    ds_write_b128 v156, v[44:47] offset:4096
    v_perm_b32 v48, v78, v62, v158
    v_perm_b32 v49, v78, v62, v160
    v_perm_b32 v50, v79, v63, v158
    v_perm_b32 v51, v79, v63, v160
    ds_write_b128 v157, v[48:51] offset:4096
    v_perm_b32 v44, v80, v64, v158
    v_perm_b32 v45, v80, v64, v160
    v_perm_b32 v46, v81, v65, v158
    v_perm_b32 v47, v81, v65, v160
    ds_write_b128 v156, v[44:47] offset:6144
    v_perm_b32 v48, v82, v66, v158
    v_perm_b32 v49, v82, v66, v160
    v_perm_b32 v50, v83, v67, v158
    v_perm_b32 v51, v83, v67, v160
    ds_write_b128 v157, v[48:51] offset:6144
    v_mov_b32 v1, s60
    v_mov_b32 v2, 1
    s_waitcnt lgkmcnt(0)
    s_mov_b64 exec, 1
    ds_add_rtn_u32 v2, v1, v2
    s_mov_b64 exec, -1
    s_waitcnt lgkmcnt(0)
    v_readfirstlane_b32 s40, v2
    s_cmp_ge_u32 s40, 3
    s_cbranch_scc1 Lbd25
Lbl26:
    ds_read_b32 v2, v1
    s_waitcnt lgkmcnt(0)
    v_readfirstlane_b32 s40, v2
    s_cmp_lt_u32 s40, 4
    s_cbranch_scc1 Lbl26
Lbd25:
    ds_read_b32 v56, v8 offset:0
    ds_read_b32 v57, v8 offset:4096
    ds_read_b32 v58, v8 offset:8192
    ds_read_b32 v59, v8 offset:12288
    ds_read_b32 v64, v9 offset:0
    ds_read_b32 v65, v9 offset:4096
    ds_read_b32 v66, v9 offset:8192
    ds_read_b32 v67, v9 offset:12288
    ds_read_b32 v72, v10 offset:0
    ds_read_b32 v73, v10 offset:4096
    ds_read_b32 v74, v10 offset:8192
    ds_read_b32 v75, v10 offset:12288
    ds_read_b32 v80, v11 offset:0
    ds_read_b32 v81, v11 offset:4096
    ds_read_b32 v82, v11 offset:8192
    ds_read_b32 v83, v11 offset:12288
    s_branch La223
La224:
    s_waitcnt vmcnt(0)
    ds_read_b32 v56, v8 offset:0
    ds_read_b32 v57, v8 offset:2048
    ds_read_b32 v58, v8 offset:4096
    ds_read_b32 v59, v8 offset:6144
    ds_read_b32 v64, v8 offset:8
    ds_read_b32 v65, v8 offset:2056
    ds_read_b32 v66, v8 offset:4104
    ds_read_b32 v67, v8 offset:6152
    ds_read_b32 v72, v10 offset:0
    ds_read_b32 v73, v10 offset:2048
    ds_read_b32 v74, v10 offset:4096
    ds_read_b32 v75, v10 offset:6144
    ds_read_b32 v80, v10 offset:8
    ds_read_b32 v81, v10 offset:2056
    ds_read_b32 v82, v10 offset:4104
    ds_read_b32 v83, v10 offset:6152
    v_mov_b32 v1, s60
    v_mov_b32 v2, 1
    s_waitcnt lgkmcnt(0)
    s_mov_b64 exec, 1
    ds_add_rtn_u32 v2, v1, v2
    s_mov_b64 exec, -1
    s_waitcnt lgkmcnt(0)
    v_readfirstlane_b32 s40, v2
    s_cmp_ge_u32 s40, 3
    s_cbranch_scc1 Lbd27
Lbl28:
    ds_read_b32 v2, v1
    s_waitcnt lgkmcnt(0)
    v_readfirstlane_b32 s40, v2
    s_cmp_lt_u32 s40, 4
    s_cbranch_scc1 Lbl28
Lbd27:
La223:
    s_waitcnt lgkmcnt(15)
    v_lshlrev_b32 v52, 16, v56
    v_and_b32 v56, v161, v56
    s_waitcnt lgkmcnt(14)
    v_lshlrev_b32 v53, 16, v57
    v_and_b32 v57, v161, v57
    s_waitcnt lgkmcnt(13)
    v_lshlrev_b32 v54, 16, v58
    v_and_b32 v58, v161, v58
    s_waitcnt lgkmcnt(12)
    v_lshlrev_b32 v55, 16, v59
    v_and_b32 v59, v161, v59
    v_mul_f32 v44, v100, v52
    v_mul_f32 v45, v104, v52
    v_fma_f32 v44, -v104, v56, v44
    v_fmac_f32 v45, v100, v56
    v_cvt_pk_bf16_f32 v84, v45, v44
    v_mul_f32 v46, v101, v53
    v_mul_f32 v47, v105, v53
    v_fma_f32 v46, -v105, v57, v46
    v_fmac_f32 v47, v101, v57
    v_cvt_pk_bf16_f32 v85, v47, v46
    v_mul_f32 v44, v102, v54
    v_mul_f32 v45, v106, v54
    v_fma_f32 v44, -v106, v58, v44
    v_fmac_f32 v45, v102, v58
    v_cvt_pk_bf16_f32 v86, v45, v44
    v_mul_f32 v46, v103, v55
    v_mul_f32 v47, v107, v55
    v_fma_f32 v46, -v107, v59, v46
    v_fmac_f32 v47, v103, v59
    v_cvt_pk_bf16_f32 v87, v47, v46
    s_nop 1
    v_mfma_f32_16x16x32_bf16 v[100:103], v[84:87], v[20:23], 0
    v_mfma_f32_16x16x32_bf16 v[104:107], v[84:87], v[24:27], 0
    s_waitcnt lgkmcnt(11)
    v_lshlrev_b32 v60, 16, v64
    v_and_b32 v64, v161, v64
    s_waitcnt lgkmcnt(10)
    v_lshlrev_b32 v61, 16, v65
    v_and_b32 v65, v161, v65
    s_waitcnt lgkmcnt(9)
    v_lshlrev_b32 v62, 16, v66
    v_and_b32 v66, v161, v66
    s_waitcnt lgkmcnt(8)
    v_lshlrev_b32 v63, 16, v67
    v_and_b32 v67, v161, v67
    v_mul_f32 v44, v108, v60
    v_mul_f32 v45, v112, v60
    v_fma_f32 v44, -v112, v64, v44
    v_fmac_f32 v45, v108, v64
    v_cvt_pk_bf16_f32 v88, v45, v44
    v_mul_f32 v46, v109, v61
    v_mul_f32 v47, v113, v61
    v_fma_f32 v46, -v113, v65, v46
    v_fmac_f32 v47, v109, v65
    v_cvt_pk_bf16_f32 v89, v47, v46
    v_mul_f32 v44, v110, v62
    v_mul_f32 v45, v114, v62
    v_fma_f32 v44, -v114, v66, v44
    v_fmac_f32 v45, v110, v66
    v_cvt_pk_bf16_f32 v90, v45, v44
    v_mul_f32 v46, v111, v63
    v_mul_f32 v47, v115, v63
    v_fma_f32 v46, -v115, v67, v46
    v_fmac_f32 v47, v111, v67
    v_cvt_pk_bf16_f32 v91, v47, v46
    s_nop 1
    v_mfma_f32_16x16x32_bf16 v[108:111], v[88:91], v[20:23], 0
    v_mfma_f32_16x16x32_bf16 v[112:115], v[88:91], v[24:27], 0
    s_waitcnt lgkmcnt(7)
    v_lshlrev_b32 v68, 16, v72
    v_and_b32 v72, v161, v72
    s_waitcnt lgkmcnt(6)
    v_lshlrev_b32 v69, 16, v73
    v_and_b32 v73, v161, v73
    s_waitcnt lgkmcnt(5)
    v_lshlrev_b32 v70, 16, v74
    v_and_b32 v74, v161, v74
    s_waitcnt lgkmcnt(4)
    v_lshlrev_b32 v71, 16, v75
    v_and_b32 v75, v161, v75
    v_mul_f32 v44, v116, v68
    v_mul_f32 v45, v120, v68
    v_fma_f32 v44, -v120, v72, v44
    v_fmac_f32 v45, v116, v72
    v_cvt_pk_bf16_f32 v92, v45, v44
    v_mul_f32 v46, v117, v69
    v_mul_f32 v47, v121, v69
    v_fma_f32 v46, -v121, v73, v46
    v_fmac_f32 v47, v117, v73
    v_cvt_pk_bf16_f32 v93, v47, v46
    v_mul_f32 v44, v118, v70
    v_mul_f32 v45, v122, v70
    v_fma_f32 v44, -v122, v74, v44
    v_fmac_f32 v45, v118, v74
    v_cvt_pk_bf16_f32 v94, v45, v44
    v_mul_f32 v46, v119, v71
    v_mul_f32 v47, v123, v71
    v_fma_f32 v46, -v123, v75, v46
    v_fmac_f32 v47, v119, v75
    v_cvt_pk_bf16_f32 v95, v47, v46
    s_nop 1
    v_mfma_f32_16x16x32_bf16 v[116:119], v[92:95], v[20:23], 0
    v_mfma_f32_16x16x32_bf16 v[120:123], v[92:95], v[24:27], 0
    s_waitcnt lgkmcnt(3)
    v_lshlrev_b32 v76, 16, v80
    v_and_b32 v80, v161, v80
    s_waitcnt lgkmcnt(2)
    v_lshlrev_b32 v77, 16, v81
    v_and_b32 v81, v161, v81
    s_waitcnt lgkmcnt(1)
    v_lshlrev_b32 v78, 16, v82
    v_and_b32 v82, v161, v82
    s_waitcnt lgkmcnt(0)
    v_lshlrev_b32 v79, 16, v83
    v_and_b32 v83, v161, v83
    v_mul_f32 v44, v124, v76
    v_mul_f32 v45, v128, v76
    v_fma_f32 v44, -v128, v80, v44
    v_fmac_f32 v45, v124, v80
    v_cvt_pk_bf16_f32 v96, v45, v44
    v_mul_f32 v46, v125, v77
    v_mul_f32 v47, v129, v77
    v_fma_f32 v46, -v129, v81, v46
    v_fmac_f32 v47, v125, v81
    v_cvt_pk_bf16_f32 v97, v47, v46
    v_mul_f32 v44, v126, v78
    v_mul_f32 v45, v130, v78
    v_fma_f32 v44, -v130, v82, v44
    v_fmac_f32 v45, v126, v82
    v_cvt_pk_bf16_f32 v98, v45, v44
    v_mul_f32 v46, v127, v79
    v_mul_f32 v47, v131, v79
    v_fma_f32 v46, -v131, v83, v46
    v_fmac_f32 v47, v127, v83
    v_cvt_pk_bf16_f32 v99, v47, v46
    s_nop 1
    v_mfma_f32_16x16x32_bf16 v[124:127], v[96:99], v[20:23], 0
    v_mfma_f32_16x16x32_bf16 v[128:131], v[96:99], v[24:27], 0
    v_mul_f32 v44, v104, v36
    v_mul_f32 v45, v100, v36
    v_fma_f32 v44, -v100, v40, v44
    v_fmac_f32 v45, v104, v40
    v_cvt_pk_bf16_f32 v84, v45, v44
    v_mul_f32 v46, v105, v37
    v_mul_f32 v47, v101, v37
    v_fma_f32 v46, -v101, v41, v46
    v_fmac_f32 v47, v105, v41
    v_cvt_pk_bf16_f32 v85, v47, v46
    v_mul_f32 v44, v106, v38
    v_mul_f32 v45, v102, v38
    v_fma_f32 v44, -v102, v42, v44
    v_fmac_f32 v45, v106, v42
    v_cvt_pk_bf16_f32 v86, v45, v44
    v_mul_f32 v46, v107, v39
    v_mul_f32 v47, v103, v39
    v_fma_f32 v46, -v103, v43, v46
    v_fmac_f32 v47, v107, v43
    v_cvt_pk_bf16_f32 v87, v47, v46
    s_nop 1
    v_mfma_f32_16x16x32_bf16 v[100:103], v[12:15], v[84:87], 0
    v_mfma_f32_16x16x32_bf16 v[104:107], v[16:19], v[84:87], 0
    v_mul_f32 v44, v112, v36
    v_mul_f32 v45, v108, v36
    v_fma_f32 v44, -v108, v40, v44
    v_fmac_f32 v45, v112, v40
    v_cvt_pk_bf16_f32 v88, v45, v44
    v_mul_f32 v46, v113, v37
    v_mul_f32 v47, v109, v37
    v_fma_f32 v46, -v109, v41, v46
    v_fmac_f32 v47, v113, v41
    v_cvt_pk_bf16_f32 v89, v47, v46
    v_mul_f32 v44, v114, v38
    v_mul_f32 v45, v110, v38
    v_fma_f32 v44, -v110, v42, v44
    v_fmac_f32 v45, v114, v42
    v_cvt_pk_bf16_f32 v90, v45, v44
    v_mul_f32 v46, v115, v39
    v_mul_f32 v47, v111, v39
    v_fma_f32 v46, -v111, v43, v46
    v_fmac_f32 v47, v115, v43
    v_cvt_pk_bf16_f32 v91, v47, v46
    s_nop 1
    v_mfma_f32_16x16x32_bf16 v[108:111], v[12:15], v[88:91], 0
    v_mfma_f32_16x16x32_bf16 v[112:115], v[16:19], v[88:91], 0
    v_mul_f32 v44, v120, v36
    v_mul_f32 v45, v116, v36
    v_fma_f32 v44, -v116, v40, v44
    v_fmac_f32 v45, v120, v40
    v_cvt_pk_bf16_f32 v92, v45, v44
    v_mul_f32 v46, v121, v37
    v_mul_f32 v47, v117, v37
    v_fma_f32 v46, -v117, v41, v46
    v_fmac_f32 v47, v121, v41
    v_cvt_pk_bf16_f32 v93, v47, v46
    v_mul_f32 v44, v122, v38
    v_mul_f32 v45, v118, v38
    v_fma_f32 v44, -v118, v42, v44
    v_fmac_f32 v45, v122, v42
    v_cvt_pk_bf16_f32 v94, v45, v44
    v_mul_f32 v46, v123, v39
    v_mul_f32 v47, v119, v39
    v_fma_f32 v46, -v119, v43, v46
    v_fmac_f32 v47, v123, v43
    v_cvt_pk_bf16_f32 v95, v47, v46
    s_nop 1
    v_mfma_f32_16x16x32_bf16 v[116:119], v[12:15], v[92:95], 0
    v_mfma_f32_16x16x32_bf16 v[120:123], v[16:19], v[92:95], 0
    v_mul_f32 v44, v128, v36
    v_mul_f32 v45, v124, v36
    v_fma_f32 v44, -v124, v40, v44
    v_fmac_f32 v45, v128, v40
    v_cvt_pk_bf16_f32 v96, v45, v44
    v_mul_f32 v46, v129, v37
    v_mul_f32 v47, v125, v37
    v_fma_f32 v46, -v125, v41, v46
    v_fmac_f32 v47, v129, v41
    v_cvt_pk_bf16_f32 v97, v47, v46
    v_mul_f32 v44, v130, v38
    v_mul_f32 v45, v126, v38
    v_fma_f32 v44, -v126, v42, v44
    v_fmac_f32 v45, v130, v42
    v_cvt_pk_bf16_f32 v98, v45, v44
    v_mul_f32 v46, v131, v39
    v_mul_f32 v47, v127, v39
    v_fma_f32 v46, -v127, v43, v46
    v_fmac_f32 v47, v131, v43
    v_cvt_pk_bf16_f32 v99, v47, v46
    s_nop 1
    v_mfma_f32_16x16x32_bf16 v[124:127], v[12:15], v[96:99], 0
    v_mfma_f32_16x16x32_bf16 v[128:131], v[16:19], v[96:99], 0
    v_bfe_u32 v1, v0, 3, 1
    v_xor_b32 v1, 1, v1
    v_cvt_pk_bf16_f32 v84, v104, v100
    v_and_or_b32 v84, v84, -2, v1
    ds_write_b32 v5, v84 offset:0
    v_cvt_pk_bf16_f32 v85, v105, v101
    v_and_or_b32 v85, v85, -2, v1
    ds_write_b32 v5, v85 offset:1024
    v_cvt_pk_bf16_f32 v86, v106, v102
    v_and_or_b32 v86, v86, -2, v1
    ds_write_b32 v5, v86 offset:2048
    v_cvt_pk_bf16_f32 v87, v107, v103
    v_and_or_b32 v87, v87, -2, v1
    ds_write_b32 v5, v87 offset:3072
    v_cvt_pk_bf16_f32 v88, v112, v108
    v_and_or_b32 v88, v88, -2, v1
    ds_write_b32 v5, v88 offset:8
    v_cvt_pk_bf16_f32 v89, v113, v109
    v_and_or_b32 v89, v89, -2, v1
    ds_write_b32 v5, v89 offset:1032
    v_cvt_pk_bf16_f32 v90, v114, v110
    v_and_or_b32 v90, v90, -2, v1
    ds_write_b32 v5, v90 offset:2056
    v_cvt_pk_bf16_f32 v91, v115, v111
    v_and_or_b32 v91, v91, -2, v1
    ds_write_b32 v5, v91 offset:3080
    v_cvt_pk_bf16_f32 v92, v120, v116
    v_and_or_b32 v92, v92, -2, v1
    ds_write_b32 v154, v92 offset:0
    v_cvt_pk_bf16_f32 v93, v121, v117
    v_and_or_b32 v93, v93, -2, v1
    ds_write_b32 v154, v93 offset:1024
    v_cvt_pk_bf16_f32 v94, v122, v118
    v_and_or_b32 v94, v94, -2, v1
    ds_write_b32 v154, v94 offset:2048
    v_cvt_pk_bf16_f32 v95, v123, v119
    v_and_or_b32 v95, v95, -2, v1
    ds_write_b32 v154, v95 offset:3072
    v_cvt_pk_bf16_f32 v96, v128, v124
    v_and_or_b32 v96, v96, -2, v1
    ds_write_b32 v154, v96 offset:8
    v_cvt_pk_bf16_f32 v97, v129, v125
    v_and_or_b32 v97, v97, -2, v1
    ds_write_b32 v154, v97 offset:1032
    v_cvt_pk_bf16_f32 v98, v130, v126
    v_and_or_b32 v98, v98, -2, v1
    ds_write_b32 v154, v98 offset:2056
    v_cvt_pk_bf16_f32 v99, v131, v127
    v_and_or_b32 v99, v99, -2, v1
    ds_write_b32 v154, v99 offset:3080
    s_add_u32 s8, s61, 8
    v_mov_b32 v1, s8
    v_mov_b32 v2, 1
    s_waitcnt lgkmcnt(0)
    s_mov_b64 exec, 1
    ds_add_rtn_u32 v2, v1, v2
    s_mov_b64 exec, -1
    s_waitcnt lgkmcnt(0)
    v_readfirstlane_b32 s40, v2
    s_cmp_ge_u32 s40, 3
    s_cbranch_scc1 Lbd29
Lbl30:
    ds_read_b32 v2, v1
    s_waitcnt lgkmcnt(0)
    v_readfirstlane_b32 s40, v2
    s_cmp_lt_u32 s40, 4
    s_cbranch_scc1 Lbl30
Lbd29:
    ds_read_b128 v[100:103], v4 offset:0
    ds_read_b128 v[104:107], v4 offset:4096
    ds_read_b128 v[108:111], v4 offset:8192
    ds_read_b128 v[112:115], v4 offset:12288
    s_waitcnt lgkmcnt(3)
    global_store_dwordx4 v3, v[100:103], s[44:45] sc1
    s_waitcnt lgkmcnt(2)
    global_store_dwordx4 v3, v[104:107], s[46:47] sc1
    s_waitcnt lgkmcnt(1)
    global_store_dwordx4 v3, v[108:111], s[48:49] sc1
    s_waitcnt lgkmcnt(0)
    global_store_dwordx4 v3, v[112:115], s[50:51] sc1
    s_setprio 0
    s_cmp_ge_u32 s3, 8
    s_cbranch_scc1 La231
    v_mov_b32 v1, 68
    v_mov_b32 v2, 1
    s_waitcnt lgkmcnt(0)
    s_mov_b64 exec, 1
    ds_add_u32 v1, v2
    s_mov_b64 exec, -1
    s_branch LA3
La231:
    s_cmp_ge_u32 s7, 33
    s_cbranch_scc1 La232
    s_setprio 3
    s_mov_b32 s52, 62208
    v_and_b32 v132, 15, v0
    v_lshrrev_b32 v133, 4, v0
    s_sub_u32 s12, s3, 8
    s_nop 0
Lc33:
    s_cmp_ge_u32 s12, 5
    s_cselect_b32 s13, 1, 0
    s_sub_u32 s8, s12, 10
    s_cmp_ge_u32 s12, 10
    s_cselect_b32 s13, s8, s13
    s_cmp_eq_u32 s13, 2
    s_cselect_b32 s14, 20, 10
    s_mov_b32 s15, 117834241
    s_cselect_b32 s15, 252314880, s15
    s_and_b32 s8, s13, 1
    s_mul_i32 s8, s8, 40
    v_mul_lo_u32 v134, v133, s14
    v_add_u32 v134, s8, v134
    s_bfe_u32 s8, s15, 524288
    v_add_u32 v136, s8, v134
    s_bfe_u32 s8, s15, 524296
    v_add_u32 v137, s8, v134
    s_bfe_u32 s8, s15, 524304
    v_add_u32 v138, s8, v134
    s_bfe_u32 s8, s15, 524312
    v_add_u32 v139, s8, v134
    s_cmp_ge_u32 s12, 10
    s_cbranch_scc1 Lc34
    s_mul_i32 s8, s13, 5
    s_sub_u32 s8, s12, s8
    s_lshl_b32 s8, s8, 4
    v_add_u32 v134, s8, v132
    v_mul_u32_u24 v136, v134, v136
    v_cvt_f32_u32 v136, v136
    v_mul_f32 v136, 0x3c4ccccd, v136
    v_mul_u32_u24 v137, v134, v137
    v_cvt_f32_u32 v137, v137
    v_mul_f32 v137, 0x3c4ccccd, v137
    v_mul_u32_u24 v138, v134, v138
    v_cvt_f32_u32 v138, v138
    v_mul_f32 v138, 0x3c4ccccd, v138
    v_mul_u32_u24 v139, v134, v139
    v_cvt_f32_u32 v139, v139
    v_mul_f32 v139, 0x3c4ccccd, v139
    v_cos_f32 v140, v136
    v_sin_f32 v144, v136
    v_cos_f32 v141, v137
    v_sin_f32 v145, v137
    v_cos_f32 v142, v138
    v_sin_f32 v146, v138
    v_cos_f32 v143, v139
    v_sin_f32 v147, v139
    v_cvt_pk_bf16_f32 v148, v140, v141
    v_cvt_pk_bf16_f32 v150, -v144, -v145
    v_cvt_pk_bf16_f32 v149, v142, v143
    v_cvt_pk_bf16_f32 v151, -v146, -v147
    s_lshl_b32 s8, s12, 10
    s_add_u32 s8, s8, s52
    v_lshl_add_u32 v135, v0, 4, s8
    ds_write_b128 v135, v[148:151]
    s_branch Lc35
Lc34:
    v_and_b32 v134, 7, v0
    v_mul_u32_u24 v136, v134, v136
    v_cvt_f32_u32 v136, v136
    v_mul_f32 v136, 0x3acccccd, v136
    v_mul_u32_u24 v137, v134, v137
    v_cvt_f32_u32 v137, v137
    v_mul_f32 v137, 0x3acccccd, v137
    v_mul_u32_u24 v138, v134, v138
    v_cvt_f32_u32 v138, v138
    v_mul_f32 v138, 0x3acccccd, v138
    v_mul_u32_u24 v139, v134, v139
    v_cvt_f32_u32 v139, v139
    v_mul_f32 v139, 0x3acccccd, v139
    v_cos_f32 v140, v136
    v_sin_f32 v144, v136
    v_cos_f32 v141, v137
    v_sin_f32 v145, v137
    v_cos_f32 v142, v138
    v_sin_f32 v146, v138
    v_cos_f32 v143, v139
    v_sin_f32 v147, v139
    s_lshl_b32 s8, s13, 11
    s_add_u32 s8, s8, 10240
    s_add_u32 s8, s8, s52
    v_lshl_add_u32 v135, v0, 4, s8
    ds_write_b128 v135, v[140:143]
    ds_write_b128 v135, v[144:147] offset:1024
Lc35:
    s_add_u32 s12, s12, 4
    s_cmp_lt_u32 s12, 13
    s_cbranch_scc1 Lc33
La232:
    v_mov_b32 v1, 52
    v_mov_b32 v2, 1
    s_waitcnt vmcnt(0) lgkmcnt(0)
    s_mov_b64 exec, 1
    ds_add_u32 v1, v2
    s_mov_b64 exec, -1
    s_branch Lfin
LB1:
    s_setprio 2
    s_cmp_ge_u32 s3, 5
    s_cselect_b32 s13, 1, 0
    s_mul_i32 s14, s13, 5
    s_sub_u32 s14, s3, s14
    v_lshrrev_b32 v5, 3, v0
    v_lshl_add_u32 v5, s14, 3, v5
    v_and_b32 v6, 7, v0
    s_lshl_b32 s15, s13, 3
    s_add_u32 s15, s15, 7
    v_sub_u32 v6, s15, v6
    v_mul_u32_u24 v3, 1296, v6
    v_lshl_add_u32 v3, v5, 2, v3
    v_add_u32 v3, 116224, v3
    s_mul_i32 s15, s4, 327680
    s_add_u32 s15, s15, 3149808
    s_lshl_b32 s8, s6, 8
    s_sub_u32 s15, s15, s8
    v_lshl_add_u32 v4, v5, 13, s15
    v_lshlrev_b32 v7, 4, v6
    v_sub_u32 v4, v4, v7
    s_mul_i32 s8, s4, 640
    v_lshl_add_u32 v1, v5, 4, s8
    global_load_dwordx4 v[8:11], v1, s[28:29]
    v_mov_b32 v20, 4294901760
    s_waitcnt vmcnt(0)
    v_lshlrev_b32 v12, 16, v8
    v_lshlrev_b32 v13, 16, v10
    v_and_b32 v14, v20, v8
    v_and_b32 v15, v20, v10
    v_lshlrev_b32 v16, 16, v9
    v_lshlrev_b32 v17, 16, v11
    v_and_b32 v18, v20, v9
    v_and_b32 v19, v20, v11
    v_mov_b32 v1, 20
    v_mov_b32 v2, 1
    s_waitcnt vmcnt(0) lgkmcnt(0)
    s_mov_b64 exec, 1
    ds_add_rtn_u32 v2, v1, v2
    s_mov_b64 exec, -1
    s_waitcnt lgkmcnt(0)
    v_readfirstlane_b32 s40, v2
    s_cmp_ge_u32 s40, 9
    s_cbranch_scc1 Lbd36
Lbl37:
    ds_read_b32 v2, v1
    s_waitcnt lgkmcnt(0)
    v_readfirstlane_b32 s40, v2
    s_cmp_lt_u32 s40, 10
    s_cbranch_scc1 Lbl37
Lbd36:
    ds_read_b32 v22, v3 offset:800
    ds_read_b32 v23, v3 offset:960
    ds_read_b32 v24, v3 offset:1120
    ds_read_b32 v25, v3 offset:1296
    ds_read_b32 v26, v3 offset:1456
    ds_read_b32 v27, v3 offset:1616
    ds_read_b32 v28, v3 offset:1776
    ds_read_b32 v29, v3 offset:1936
    ds_read_b32 v30, v3 offset:2096
    ds_read_b32 v31, v3 offset:2256
    ds_read_b32 v32, v3 offset:2416
    ds_read_b32 v34, v3 offset:22032
    ds_read_b32 v35, v3 offset:22192
    ds_read_b32 v36, v3 offset:22352
    ds_read_b32 v37, v3 offset:22512
    ds_read_b32 v38, v3 offset:22672
    ds_read_b32 v39, v3 offset:22832
    ds_read_b32 v40, v3 offset:22992
    ds_read_b32 v41, v3 offset:23152
    v_add_u32 v80, 4096, v4
    s_waitcnt lgkmcnt(15)
    v_lshlrev_b32 v42, 16, v22
    v_and_b32 v43, v20, v22
    v_lshlrev_b32 v44, 16, v23
    v_and_b32 v45, v20, v23
    v_lshlrev_b32 v46, 16, v24
    v_and_b32 v47, v20, v24
    v_lshlrev_b32 v48, 16, v25
    v_and_b32 v49, v20, v25
    v_mul_f32 v64, v42, v18
    v_fmac_f32 v64, v44, v16
    v_fmac_f32 v64, v46, v14
    v_fmac_f32 v64, v48, v12
    s_waitcnt lgkmcnt(7)
    v_lshlrev_b32 v66, 16, v34
    v_mul_f32 v76, v64, v66
    v_mul_f32 v65, v43, v19
    v_fmac_f32 v65, v45, v17
    v_fmac_f32 v65, v47, v15
    v_fmac_f32 v65, v49, v13
    v_and_b32 v67, v20, v34
    v_mul_f32 v77, v65, v67
    v_lshlrev_b32 v50, 16, v26
    v_and_b32 v51, v20, v26
    v_mul_f32 v64, v44, v18
    v_fmac_f32 v64, v46, v16
    v_fmac_f32 v64, v48, v14
    v_fmac_f32 v64, v50, v12
    s_waitcnt lgkmcnt(6)
    v_lshlrev_b32 v66, 16, v35
    v_mul_f32 v78, v64, v66
    v_mul_f32 v65, v45, v19
    v_fmac_f32 v65, v47, v17
    v_fmac_f32 v65, v49, v15
    v_fmac_f32 v65, v51, v13
    v_and_b32 v67, v20, v35
    v_mul_f32 v79, v65, v67
    v_cvt_pk_bf16_f32 v71, v78, v76
    v_or_b32 v71, 65537, v71
    v_cvt_pk_bf16_f32 v75, v79, v77
    v_or_b32 v75, 65537, v75
    v_lshlrev_b32 v52, 16, v27
    v_and_b32 v53, v20, v27
    v_mul_f32 v64, v46, v18
    v_fmac_f32 v64, v48, v16
    v_fmac_f32 v64, v50, v14
    v_fmac_f32 v64, v52, v12
    s_waitcnt lgkmcnt(5)
    v_lshlrev_b32 v66, 16, v36
    v_mul_f32 v76, v64, v66
    v_mul_f32 v65, v47, v19
    v_fmac_f32 v65, v49, v17
    v_fmac_f32 v65, v51, v15
    v_fmac_f32 v65, v53, v13
    v_and_b32 v67, v20, v36
    v_mul_f32 v77, v65, v67
    v_lshlrev_b32 v54, 16, v28
    v_and_b32 v55, v20, v28
    v_mul_f32 v64, v48, v18
    v_fmac_f32 v64, v50, v16
    v_fmac_f32 v64, v52, v14
    v_fmac_f32 v64, v54, v12
    s_waitcnt lgkmcnt(4)
    v_lshlrev_b32 v66, 16, v37
    v_mul_f32 v78, v64, v66
    v_mul_f32 v65, v49, v19
    v_fmac_f32 v65, v51, v17
    v_fmac_f32 v65, v53, v15
    v_fmac_f32 v65, v55, v13
    v_and_b32 v67, v20, v37
    v_mul_f32 v79, v65, v67
    v_cvt_pk_bf16_f32 v70, v78, v76
    v_and_or_b32 v70, v70, -2, s101
    v_cvt_pk_bf16_f32 v74, v79, v77
    v_and_or_b32 v74, v74, -2, s101
    v_lshlrev_b32 v56, 16, v29
    v_and_b32 v57, v20, v29
    v_mul_f32 v64, v50, v18
    v_fmac_f32 v64, v52, v16
    v_fmac_f32 v64, v54, v14
    v_fmac_f32 v64, v56, v12
    s_waitcnt lgkmcnt(3)
    v_lshlrev_b32 v66, 16, v38
    v_mul_f32 v76, v64, v66
    v_mul_f32 v65, v51, v19
    v_fmac_f32 v65, v53, v17
    v_fmac_f32 v65, v55, v15
    v_fmac_f32 v65, v57, v13
    v_and_b32 v67, v20, v38
    v_mul_f32 v77, v65, v67
    v_lshlrev_b32 v58, 16, v30
    v_and_b32 v59, v20, v30
    v_mul_f32 v64, v52, v18
    v_fmac_f32 v64, v54, v16
    v_fmac_f32 v64, v56, v14
    v_fmac_f32 v64, v58, v12
    s_waitcnt lgkmcnt(2)
    v_lshlrev_b32 v66, 16, v39
    v_mul_f32 v78, v64, v66
    v_mul_f32 v65, v53, v19
    v_fmac_f32 v65, v55, v17
    v_fmac_f32 v65, v57, v15
    v_fmac_f32 v65, v59, v13
    v_and_b32 v67, v20, v39
    v_mul_f32 v79, v65, v67
    v_cvt_pk_bf16_f32 v69, v78, v76
    v_and_or_b32 v69, v69, s100, 1
    v_cvt_pk_bf16_f32 v73, v79, v77
    v_and_or_b32 v73, v73, s100, 1
    v_lshlrev_b32 v60, 16, v31
    v_and_b32 v61, v20, v31
    v_mul_f32 v64, v54, v18
    v_fmac_f32 v64, v56, v16
    v_fmac_f32 v64, v58, v14
    v_fmac_f32 v64, v60, v12
    s_waitcnt lgkmcnt(1)
    v_lshlrev_b32 v66, 16, v40
    v_mul_f32 v76, v64, v66
    v_mul_f32 v65, v55, v19
    v_fmac_f32 v65, v57, v17
    v_fmac_f32 v65, v59, v15
    v_fmac_f32 v65, v61, v13
    v_and_b32 v67, v20, v40
    v_mul_f32 v77, v65, v67
    v_lshlrev_b32 v62, 16, v32
    v_and_b32 v63, v20, v32
    v_mul_f32 v64, v56, v18
    v_fmac_f32 v64, v58, v16
    v_fmac_f32 v64, v60, v14
    v_fmac_f32 v64, v62, v12
    s_waitcnt lgkmcnt(0)
    v_lshlrev_b32 v66, 16, v41
    v_mul_f32 v78, v64, v66
    v_mul_f32 v65, v57, v19
    v_fmac_f32 v65, v59, v17
    v_fmac_f32 v65, v61, v15
    v_fmac_f32 v65, v63, v13
    v_and_b32 v67, v20, v41
    v_mul_f32 v79, v65, v67
    v_cvt_pk_bf16_f32 v68, v78, v76
    v_and_b32 v68, 4294901758, v68
    v_cvt_pk_bf16_f32 v72, v79, v77
    v_and_b32 v72, 4294901758, v72
    global_store_dwordx4 v4, v[68:71], s[38:39] sc1
    global_store_dwordx4 v80, v[72:75], s[38:39] sc1
    s_setprio 0
    s_branch LB2
LauxO:
    s_sub_u32 s62, s3, 10
    s_lshl_b32 s62, s62, 11
    v_lshlrev_b32 v1, 4, v0
    v_add_u32 v3, s62, v1
    v_subrev_u32 v4, 128, v1
    v_subrev_u32 v5, 112, v1
    v_add_u32 v7, 256, v1
    v_add_u32 v6, s62, v7
    v_mov_b32 v8, 0
    v_mov_b32 v9, 0
    v_mov_b32 v10, 0
    v_mov_b32 v11, 0
    s_mul_i32 s8, 0, 30976
    s_add_u32 s8, s8, 21776
    v_lshl_add_u32 v1, v0, 4, s8
    ds_write_b128 v1, v[8:11]
    s_mov_b64 exec, 255
    ds_write_b128 v1, v[8:11] offset:1024
    s_mov_b64 exec, -1
    s_mul_i32 s8, 1, 30976
    s_add_u32 s8, s8, 21776
    v_lshl_add_u32 v1, v0, 4, s8
    ds_write_b128 v1, v[8:11]
    s_mov_b64 exec, 255
    ds_write_b128 v1, v[8:11] offset:1024
    s_mov_b64 exec, -1
    s_mul_i32 s8, 2, 30976
    s_add_u32 s8, s8, 21776
    v_lshl_add_u32 v1, v0, 4, s8
    ds_write_b128 v1, v[8:11]
    s_mov_b64 exec, 255
    ds_write_b128 v1, v[8:11] offset:1024
    s_mov_b64 exec, -1
    v_mov_b32 v1, 20
    s_nop 1
Lw38:
    s_sleep 1
    ds_read_b32 v2, v1
    s_waitcnt lgkmcnt(0)
    v_readfirstlane_b32 s40, v2
    s_cmp_lt_u32 s40, 1
    s_cbranch_scc1 Lw38
    s_add_u32 s8, s53, 0
    s_lshl_b32 s8, s8, 12
    s_add_u32 s44, s30, s8
    s_addc_u32 s45, s31, 0
    s_and_b32 s45, s45, 65535
    s_mov_b32 s46, 4096
    s_mov_b32 s47, 131072
    buffer_load_dwordx4 v[20:23], v3, s[44:47], 0 offen offset:0
    buffer_load_dwordx2 v[24:25], v3, s[44:47], 0 offen offset:16
    buffer_load_dwordx4 v[26:29], v3, s[44:47], 0 offen offset:1024
    buffer_load_dwordx2 v[30:31], v3, s[44:47], 0 offen offset:1040
    buffer_load_dwordx4 v[32:35], v4, s[44:47], 0 offen offset:0
    buffer_load_dwordx2 v[36:37], v5, s[44:47], 0 offen offset:0
    s_add_u32 s8, s53, 1
    s_lshl_b32 s8, s8, 12
    s_add_u32 s44, s30, s8
    s_addc_u32 s45, s31, 0
    s_and_b32 s45, s45, 65535
    s_mov_b32 s46, 4096
    s_mov_b32 s47, 131072
    buffer_load_dwordx4 v[38:41], v3, s[44:47], 0 offen offset:0
    buffer_load_dwordx2 v[42:43], v3, s[44:47], 0 offen offset:16
    buffer_load_dwordx4 v[44:47], v3, s[44:47], 0 offen offset:1024
    buffer_load_dwordx2 v[48:49], v3, s[44:47], 0 offen offset:1040
    buffer_load_dwordx4 v[50:53], v4, s[44:47], 0 offen offset:0
    buffer_load_dwordx2 v[54:55], v5, s[44:47], 0 offen offset:0
    s_add_u32 s8, s53, 2
    s_lshl_b32 s8, s8, 12
    s_add_u32 s44, s30, s8
    s_addc_u32 s45, s31, 0
    s_and_b32 s45, s45, 65535
    s_mov_b32 s46, 4096
    s_mov_b32 s47, 131072
    buffer_load_dwordx4 v[56:59], v3, s[44:47], 0 offen offset:0
    buffer_load_dwordx2 v[60:61], v3, s[44:47], 0 offen offset:16
    buffer_load_dwordx4 v[62:65], v3, s[44:47], 0 offen offset:1024
    buffer_load_dwordx2 v[66:67], v3, s[44:47], 0 offen offset:1040
    buffer_load_dwordx4 v[68:71], v4, s[44:47], 0 offen offset:0
    buffer_load_dwordx2 v[72:73], v5, s[44:47], 0 offen offset:0
    s_waitcnt vmcnt(17)
    v_alignbit_b32 v8, v21, v20, 16
    v_alignbit_b32 v9, v22, v21, 16
    v_alignbit_b32 v10, v23, v22, 16
    s_waitcnt vmcnt(16)
    v_alignbit_b32 v11, v24, v23, 16
    ds_write_b128 v6, v[8:11] offset:128
    v_alignbit_b32 v12, v22, v21, 16
    v_alignbit_b32 v13, v23, v22, 16
    v_alignbit_b32 v14, v24, v23, 16
    v_alignbit_b32 v15, v25, v24, 16
    ds_write_b128 v6, v[12:15] offset:4352
    ds_write_b128 v6, v[22:25] offset:12816
    v_mov_b32 v16, v21
    v_mov_b32 v17, v22
    v_mov_b32 v18, v23
    v_mov_b32 v19, v24
    ds_write_b128 v6, v[16:19] offset:8592
    s_waitcnt vmcnt(15)
    v_alignbit_b32 v8, v27, v26, 16
    v_alignbit_b32 v9, v28, v27, 16
    v_alignbit_b32 v10, v29, v28, 16
    s_waitcnt vmcnt(14)
    v_alignbit_b32 v11, v30, v29, 16
    ds_write_b128 v6, v[8:11] offset:1152
    v_alignbit_b32 v12, v28, v27, 16
    v_alignbit_b32 v13, v29, v28, 16
    v_alignbit_b32 v14, v30, v29, 16
    v_alignbit_b32 v15, v31, v30, 16
    ds_write_b128 v6, v[12:15] offset:5376
    ds_write_b128 v6, v[28:31] offset:13840
    v_mov_b32 v16, v27
    v_mov_b32 v17, v28
    v_mov_b32 v18, v29
    v_mov_b32 v19, v30
    ds_write_b128 v6, v[16:19] offset:9616
    s_mov_b64 exec, 255
    s_waitcnt vmcnt(13)
    v_alignbit_b32 v8, v33, v32, 16
    v_alignbit_b32 v9, v34, v33, 16
    v_alignbit_b32 v10, v35, v34, 16
    s_waitcnt vmcnt(12)
    v_alignbit_b32 v11, v36, v35, 16
    ds_write_b128 v7, v[8:11] offset:0
    v_alignbit_b32 v12, v34, v33, 16
    v_alignbit_b32 v13, v35, v34, 16
    v_alignbit_b32 v14, v36, v35, 16
    v_alignbit_b32 v15, v37, v36, 16
    ds_write_b128 v7, v[12:15] offset:4224
    ds_write_b128 v7, v[34:37] offset:12688
    v_mov_b32 v16, v33
    v_mov_b32 v17, v34
    v_mov_b32 v18, v35
    v_mov_b32 v19, v36
    ds_write_b128 v7, v[16:19] offset:8464
    s_mov_b64 exec, -1
    v_add_u32 v6, 30976, v6
    v_add_u32 v7, 30976, v7
    s_waitcnt vmcnt(11)
    v_alignbit_b32 v8, v39, v38, 16
    v_alignbit_b32 v9, v40, v39, 16
    v_alignbit_b32 v10, v41, v40, 16
    s_waitcnt vmcnt(10)
    v_alignbit_b32 v11, v42, v41, 16
    ds_write_b128 v6, v[8:11] offset:128
    v_alignbit_b32 v12, v40, v39, 16
    v_alignbit_b32 v13, v41, v40, 16
    v_alignbit_b32 v14, v42, v41, 16
    v_alignbit_b32 v15, v43, v42, 16
    ds_write_b128 v6, v[12:15] offset:4352
    ds_write_b128 v6, v[40:43] offset:12816
    v_mov_b32 v16, v39
    v_mov_b32 v17, v40
    v_mov_b32 v18, v41
    v_mov_b32 v19, v42
    ds_write_b128 v6, v[16:19] offset:8592
    s_waitcnt vmcnt(9)
    v_alignbit_b32 v8, v45, v44, 16
    v_alignbit_b32 v9, v46, v45, 16
    v_alignbit_b32 v10, v47, v46, 16
    s_waitcnt vmcnt(8)
    v_alignbit_b32 v11, v48, v47, 16
    ds_write_b128 v6, v[8:11] offset:1152
    v_alignbit_b32 v12, v46, v45, 16
    v_alignbit_b32 v13, v47, v46, 16
    v_alignbit_b32 v14, v48, v47, 16
    v_alignbit_b32 v15, v49, v48, 16
    ds_write_b128 v6, v[12:15] offset:5376
    ds_write_b128 v6, v[46:49] offset:13840
    v_mov_b32 v16, v45
    v_mov_b32 v17, v46
    v_mov_b32 v18, v47
    v_mov_b32 v19, v48
    ds_write_b128 v6, v[16:19] offset:9616
    s_mov_b64 exec, 255
    s_waitcnt vmcnt(7)
    v_alignbit_b32 v8, v51, v50, 16
    v_alignbit_b32 v9, v52, v51, 16
    v_alignbit_b32 v10, v53, v52, 16
    s_waitcnt vmcnt(6)
    v_alignbit_b32 v11, v54, v53, 16
    ds_write_b128 v7, v[8:11] offset:0
    v_alignbit_b32 v12, v52, v51, 16
    v_alignbit_b32 v13, v53, v52, 16
    v_alignbit_b32 v14, v54, v53, 16
    v_alignbit_b32 v15, v55, v54, 16
    ds_write_b128 v7, v[12:15] offset:4224
    ds_write_b128 v7, v[52:55] offset:12688
    v_mov_b32 v16, v51
    v_mov_b32 v17, v52
    v_mov_b32 v18, v53
    v_mov_b32 v19, v54
    ds_write_b128 v7, v[16:19] offset:8464
    s_mov_b64 exec, -1
    v_add_u32 v6, 30976, v6
    v_add_u32 v7, 30976, v7
    s_waitcnt vmcnt(5)
    v_alignbit_b32 v8, v57, v56, 16
    v_alignbit_b32 v9, v58, v57, 16
    v_alignbit_b32 v10, v59, v58, 16
    s_waitcnt vmcnt(4)
    v_alignbit_b32 v11, v60, v59, 16
    ds_write_b128 v6, v[8:11] offset:128
    v_alignbit_b32 v12, v58, v57, 16
    v_alignbit_b32 v13, v59, v58, 16
    v_alignbit_b32 v14, v60, v59, 16
    v_alignbit_b32 v15, v61, v60, 16
    ds_write_b128 v6, v[12:15] offset:4352
    ds_write_b128 v6, v[58:61] offset:12816
    v_mov_b32 v16, v57
    v_mov_b32 v17, v58
    v_mov_b32 v18, v59
    v_mov_b32 v19, v60
    ds_write_b128 v6, v[16:19] offset:8592
    s_waitcnt vmcnt(3)
    v_alignbit_b32 v8, v63, v62, 16
    v_alignbit_b32 v9, v64, v63, 16
    v_alignbit_b32 v10, v65, v64, 16
    s_waitcnt vmcnt(2)
    v_alignbit_b32 v11, v66, v65, 16
    ds_write_b128 v6, v[8:11] offset:1152
    v_alignbit_b32 v12, v64, v63, 16
    v_alignbit_b32 v13, v65, v64, 16
    v_alignbit_b32 v14, v66, v65, 16
    v_alignbit_b32 v15, v67, v66, 16
    ds_write_b128 v6, v[12:15] offset:5376
    ds_write_b128 v6, v[64:67] offset:13840
    v_mov_b32 v16, v63
    v_mov_b32 v17, v64
    v_mov_b32 v18, v65
    v_mov_b32 v19, v66
    ds_write_b128 v6, v[16:19] offset:9616
    s_mov_b64 exec, 255
    s_waitcnt vmcnt(1)
    v_alignbit_b32 v8, v69, v68, 16
    v_alignbit_b32 v9, v70, v69, 16
    v_alignbit_b32 v10, v71, v70, 16
    s_waitcnt vmcnt(0)
    v_alignbit_b32 v11, v72, v71, 16
    ds_write_b128 v7, v[8:11] offset:0
    v_alignbit_b32 v12, v70, v69, 16
    v_alignbit_b32 v13, v71, v70, 16
    v_alignbit_b32 v14, v72, v71, 16
    v_alignbit_b32 v15, v73, v72, 16
    ds_write_b128 v7, v[12:15] offset:4224
    ds_write_b128 v7, v[70:73] offset:12688
    v_mov_b32 v16, v69
    v_mov_b32 v17, v70
    v_mov_b32 v18, v71
    v_mov_b32 v19, v72
    ds_write_b128 v7, v[16:19] offset:8464
    s_mov_b64 exec, -1
    v_mov_b32 v1, 28
    v_mov_b32 v2, 2
    s_waitcnt lgkmcnt(0)
    s_mov_b64 exec, 1
    ds_add_u32 v1, v2
    s_mov_b64 exec, -1
    s_branch LB2
LB2:
    s_waitcnt lgkmcnt(0)
    s_lshr_b32 s9, s3, 2
    s_and_b32 s10, s3, 3
    s_mul_i32 s15, s9, 30976
    s_add_u32 s15, s15, 17168
    v_lshrrev_b32 v1, 3, v0
    v_lshlrev_b32 v1, 4, v1
    v_lshl_add_u32 v3, v0, 4, v1
    s_mul_i32 s8, s10, 1152
    s_add_u32 s8, s8, s15
    v_add_u32 v3, s8, v3
    s_add_u32 s13, s53, s9
    s_lshl_b32 s8, s13, 12
    s_lshl_b32 s12, s10, 10
    s_add_u32 s8, s8, s12
    s_add_u32 s8, s8, 3145728
    v_lshl_add_u32 v12, v0, 4, s8
    s_lshl_b32 s60, s9, 2
    s_add_u32 s60, s60, 80
    s_sub_u32 s11, s10, s9
    s_and_b32 s11, s11, 3
    s_lshl2_add_u32 s99, s9, s11
    s_or_b32 s99, s99, 16
    s_cmp_lt_u32 s7, 33
    s_cselect_b32 s63, 1, 0
    s_cmp_eq_u32 s5, 0
    s_cselect_b32 s63, s63, 0
    s_cmp_eq_u32 s63, 0
    s_cbranch_scc1 Lb239
    s_mov_b32 s56, 43385362
    s_mov_b32 s57, 45548083
    s_lshl_b32 s8, s10, 4
    s_lshr_b64 s[56:57], s[56:57], s8
    s_and_b32 s99, s56, 32767
Lb239:
    s_mov_b32 s62, 1
LB2p:
    s_bfe_u32 s9, s99, 131074
    s_and_b32 s11, s99, 3
    s_add_u32 s13, s53, s9
    s_mul_i32 s15, s9, 30976
    s_add_u32 s15, s15, 17168
    v_and_b32 v15, 15, v0
    v_lshrrev_b32 v16, 4, v0
    v_mov_b32 v14, 4294901760
    v_and_b32 v1, 1, v0
    v_mul_u32_u24 v17, 8464, v1
    v_bfe_u32 v1, v0, 1, 1
    v_mul_u32_u24 v1, 4224, v1
    v_add_u32 v17, v17, v1
    v_bfe_u32 v1, v0, 2, 2
    v_lshl_add_u32 v17, v1, 5, v17
    s_cmp_eq_u32 s11, 0
    s_cselect_b32 s12, 1, 0
    s_add_u32 s14, s12, 8
    v_lshl_add_u32 v17, v16, s14, v17
    s_cmp_eq_u32 s11, 1
    s_cselect_b32 s14, 2048, 0
    s_cmp_eq_u32 s11, 3
    s_cselect_b32 s14, 1040, s14
    s_add_u32 s8, s15, s14
    s_sub_u32 s8, s8, 16912
    v_add_u32 v17, s8, v17
    s_add_u32 s14, s12, 1
    v_lshlrev_b32 v1, s14, v16
    v_sub_u32 v1, v1, v15
    s_lshl_b32 s14, s12, 4
    s_sub_u32 s14, 31, s14
    v_add_u32 v1, s14, v1
    v_mul_u32_u24 v18, 144, v1
    v_add_u32 v18, s15, v18
    s_cmp_eq_u32 s11, 2
    s_cselect_b32 s14, 31, 15
    v_sub_u32 v1, s14, v15
    v_mul_u32_u24 v20, 144, v1
    v_add_u32 v20, s15, v20
    v_lshlrev_b32 v1, 5, v16
    v_sub_u32 v20, v20, v1
    s_add_u32 s59, s15, 5872
    v_lshl_add_u32 v21, v0, 4, s59
    s_cmp_lg_u32 s11, 3
    s_cbranch_scc1 Lb240
    v_and_b32 v1, 7, v0
    v_lshlrev_b32 v2, 1, v16
    v_sub_u32 v2, v2, v1
    v_add_u32 v2, 31, v2
    v_mul_u32_u24 v18, 144, v2
    v_add_u32 v18, s15, v18
    v_and_b32 v2, 8, v0
    v_xor_b32 v2, 8, v2
    v_lshl_add_u32 v18, v2, 1, v18
    v_lshl_add_u32 v19, v2, 1, v18
    v_lshl_add_u32 v1, v16, 3, v1
    v_lshlrev_b32 v1, 4, v1
    v_and_b32 v2, 8, v0
    v_lshl_add_u32 v1, v2, 7, v1
    v_add_u32 v21, s59, v1
    s_nop 1
Lb240:
    s_lshl_b32 s8, s13, 1
    s_sub_u32 s8, s8, s96
    s_lshl_b32 s8, s8, 3
    s_lshr_b64 s[56:57], s[54:55], s8
    s_lshl_b32 s58, s56, 16
    s_cmp_gt_u32 s3, 5
    s_cselect_b32 s98, 2, 1
    s_sub_u32 s98, s3, s98
    s_min_u32 s98, s98, 8
    s_cmp_lg_u32 s12, 0
    s_cselect_b32 s98, 8, s98
    v_mov_b32 v28, 0
    v_mov_b32 v29, 0
    v_mov_b32 v30, 0
    v_mov_b32 v31, 0
    v_mov_b32 v32, 0
    v_mov_b32 v33, 0
    v_mov_b32 v34, 0
    v_mov_b32 v35, 0
    v_mov_b32 v36, 0
    v_mov_b32 v37, 0
    v_mov_b32 v38, 0
    v_mov_b32 v39, 0
    v_mov_b32 v40, 0
    v_mov_b32 v41, 0
    v_mov_b32 v42, 0
    v_mov_b32 v43, 0
    s_lshl_b32 s14, s9, 3
    s_add_u32 s14, s14, 96
    v_mov_b32 v27, s14
    v_and_b32 v2, 7, v0
    v_lshl_add_u32 v2, v16, 3, v2
    s_lshl_b32 s8, s12, 11
    s_add_u32 s8, s8, s59
    s_add_u32 s8, s8, 4096
    v_lshl_add_u32 v22, v2, 4, s8
    v_sub_u32 v1, 15, v15
    v_lshlrev_b32 v2, 1, v16
    v_sub_u32 v2, 6, v2
    v_xor_b32 v2, v1, v2
    v_and_b32 v2, 7, v2
    v_lshlrev_b32 v2, 4, v2
    v_lshl_add_u32 v23, v1, 7, v2
    v_add_u32 v23, s8, v23
    v_xor_b32 v24, 16, v23
    v_lshrrev_b32 v1, 3, v0
    v_xor_b32 v2, v1, v0
    v_and_b32 v2, 7, v2
    v_lshlrev_b32 v2, 4, v2
    v_lshl_add_u32 v25, v1, 7, v2
    v_add_u32 v25, s8, v25
    s_lshl_b32 s8, s13, 12
    s_lshl_b32 s14, s12, 11
    s_sub_u32 s8, s8, s14
    s_add_u32 s8, s8, 3147776
    v_lshl_add_u32 v26, v0, 4, s8
    s_cmp_eq_u32 s62, 0
    s_cbranch_scc1 LB2go
    s_cmp_lg_u32 s5, 0
    s_cbranch_scc1 Lb242
    v_mov_b32 v1, 40
    s_nop 1
Lw43:
    s_sleep 1
    ds_read_b32 v2, v1
    s_waitcnt lgkmcnt(0)
    v_readfirstlane_b32 s40, v2
    s_cmp_lt_u32 s40, 1
    s_cbranch_scc1 Lw43
    s_branch Lb241
Lb242:
    s_cmp_ge_u32 s3, 10
    s_cbranch_scc1 Lb244
    v_mov_b32 v1, 24
    v_mov_b32 v2, 1
    s_waitcnt vmcnt(0) lgkmcnt(0)
    s_mov_b64 exec, 1
    ds_add_u32 v1, v2
    s_mov_b64 exec, -1
Lb244:
    v_mov_b32 v1, 24
    s_nop 1
Lw45:
    s_sleep 1
    ds_read_b32 v2, v1
    s_waitcnt lgkmcnt(0)
    v_readfirstlane_b32 s40, v2
    s_cmp_lt_u32 s40, 10
    s_cbranch_scc1 Lw45
Lb241:
    s_lshl_b32 s8, s63, 12
    v_subrev_u32 v13, s8, v12
    s_mov_b32 s41, 32768
    s_nop 0
Lg46:
    global_load_dwordx4 v[4:7], v12, s[38:39] sc1
    global_load_dwordx4 v[8:11], v13, s[38:39] sc1
    s_sub_u32 s41, s41, 1
    s_waitcnt vmcnt(1)
    v_bitop3_b32 v1, v7, v4, v4 bitop3:0xcf
    v_bitop3_b32 v1, v1, v5, 1 bitop3:0xf6
    v_bitop3_b32 v1, v1, v6, s101 bitop3:0xf6
    s_waitcnt vmcnt(0)
    v_bitop3_b32 v1, v1, v11, v8 bitop3:0xfb
    v_bitop3_b32 v1, v1, v9, 1 bitop3:0xf6
    v_bitop3_b32 v1, v1, v10, s101 bitop3:0xf6
    v_and_b32 v1, 65537, v1
    v_cmp_ne_u32 vcc, 0, v1
    s_nop 3
    s_cbranch_scc1 Lg47
    s_cbranch_vccz Lg47
    s_sleep 8
    s_branch Lg46
Lg47:
    s_cmp_eq_u32 s63, 0
    s_cbranch_scc1 Lb248
    v_subrev_u32 v1, 30976, v3
    ds_write_b128 v1, v[8:11]
    s_nop 0
Lb248:
    ds_write_b128 v3, v[4:7]
    v_mov_b32 v1, 28
    s_nop 1
Lbl49:
    ds_read_b32 v2, v1
    s_waitcnt lgkmcnt(0)
    v_readfirstlane_b32 s40, v2
    s_cmp_lt_u32 s40, 4
    s_cbranch_scc1 Lbl49
Lbd50:
    v_mov_b32 v1, s60
    v_mov_b32 v2, 1
    s_waitcnt lgkmcnt(0)
    s_mov_b64 exec, 1
    ds_add_rtn_u32 v2, v1, v2
    s_mov_b64 exec, -1
    s_waitcnt lgkmcnt(0)
    v_readfirstlane_b32 s40, v2
    s_cmp_ge_u32 s40, 3
    s_cbranch_scc1 Lbd51
Lbl52:
    ds_read_b32 v2, v1
    s_waitcnt lgkmcnt(0)
    v_readfirstlane_b32 s40, v2
    s_cmp_lt_u32 s40, 4
    s_cbranch_scc1 Lbl52
Lbd51:
LB2go:
    s_cmp_eq_u32 s11, 3
    s_cbranch_scc1 LB2hi
    ds_read_b128 v[96:99], v18 offset:0
    ds_read_b128 v[48:51], v17 offset:16
    ds_read_b128 v[100:103], v18 offset:16
    ds_read_b128 v[52:55], v17 offset:32
    ds_read_b128 v[104:107], v18 offset:32
    ds_read_b128 v[56:59], v17 offset:48
    ds_read_b128 v[108:111], v18 offset:48
    ds_read_b128 v[60:63], v17 offset:64
    s_cmp_eq_u32 s11, 0
    s_cbranch_scc1 Lb253
    s_setprio 1
    ds_read_b128 v[4:7], v20 offset:96
    ds_read_b128 v[8:11], v20 offset:112
    s_waitcnt lgkmcnt(0)
    v_and_b32 v28, v14, v11
    v_mul_f32 v28, s58, v28
    v_lshlrev_b32 v29, 16, v11
    v_mul_f32 v29, s58, v29
    v_and_b32 v30, v14, v10
    v_mul_f32 v30, s58, v30
    v_lshlrev_b32 v31, 16, v10
    v_mul_f32 v31, s58, v31
    v_and_b32 v32, v14, v9
    v_mul_f32 v32, s58, v32
    v_lshlrev_b32 v33, 16, v9
    v_mul_f32 v33, s58, v33
    v_and_b32 v34, v14, v8
    v_mul_f32 v34, s58, v34
    v_lshlrev_b32 v35, 16, v8
    v_mul_f32 v35, s58, v35
    v_and_b32 v36, v14, v7
    v_mul_f32 v36, s58, v36
    v_lshlrev_b32 v37, 16, v7
    v_mul_f32 v37, s58, v37
    v_and_b32 v38, v14, v6
    v_mul_f32 v38, s58, v38
    v_lshlrev_b32 v39, 16, v6
    v_mul_f32 v39, s58, v39
    v_and_b32 v40, v14, v5
    v_mul_f32 v40, s58, v40
    v_lshlrev_b32 v41, 16, v5
    v_mul_f32 v41, s58, v41
    v_and_b32 v42, v14, v4
    v_mul_f32 v42, s58, v42
    v_lshlrev_b32 v43, 16, v4
    v_mul_f32 v43, s58, v43
    s_nop 1
Lb253:
    s_waitcnt lgkmcnt(6)
    v_mfma_f32_16x16x32_bf16 v[36:39], v[48:51], v[96:99], v[36:39]
    s_waitcnt lgkmcnt(4)
    v_mfma_f32_16x16x32_bf16 v[40:43], v[50:53], v[96:99], v[40:43]
    ds_read_b128 v[112:115], v18 offset:64
    v_mfma_f32_16x16x32_bf16 v[28:31], v[48:51], v[100:103], v[28:31]
    v_mfma_f32_16x16x32_bf16 v[32:35], v[50:53], v[100:103], v[32:35]
    ds_read_b128 v[64:67], v17 offset:80
    v_mfma_f32_16x16x32_bf16 v[36:39], v[52:55], v[100:103], v[36:39]
    s_waitcnt lgkmcnt(4)
    v_mfma_f32_16x16x32_bf16 v[40:43], v[54:57], v[100:103], v[40:43]
    ds_read_b128 v[116:119], v18 offset:80
    v_mfma_f32_16x16x32_bf16 v[28:31], v[52:55], v[104:107], v[28:31]
    v_mfma_f32_16x16x32_bf16 v[32:35], v[54:57], v[104:107], v[32:35]
    ds_read_b128 v[44:47], v17 offset:96
    ds_read_b64 v[68:69], v17 offset:96
    v_mfma_f32_16x16x32_bf16 v[36:39], v[56:59], v[104:107], v[36:39]
    s_waitcnt lgkmcnt(5)
    v_mfma_f32_16x16x32_bf16 v[40:43], v[58:61], v[104:107], v[40:43]
    ds_read_b128 v[96:99], v18 offset:96
    v_mfma_f32_16x16x32_bf16 v[28:31], v[56:59], v[108:111], v[28:31]
    v_mfma_f32_16x16x32_bf16 v[32:35], v[58:61], v[108:111], v[32:35]
    ds_read_b128 v[48:51], v17 offset:112
    v_mfma_f32_16x16x32_bf16 v[36:39], v[60:63], v[108:111], v[36:39]
    s_waitcnt lgkmcnt(5)
    v_mfma_f32_16x16x32_bf16 v[40:43], v[62:65], v[108:111], v[40:43]
    ds_read_b128 v[100:103], v18 offset:112
    v_mfma_f32_16x16x32_bf16 v[28:31], v[60:63], v[112:115], v[28:31]
    v_mfma_f32_16x16x32_bf16 v[32:35], v[62:65], v[112:115], v[32:35]
    ds_read_b128 v[52:55], v17 offset:128
    v_mfma_f32_16x16x32_bf16 v[36:39], v[64:67], v[112:115], v[36:39]
    s_waitcnt lgkmcnt(4)
    v_mfma_f32_16x16x32_bf16 v[40:43], v[66:69], v[112:115], v[40:43]
    ds_read_b128 v[104:107], v18 offset:144
    v_mfma_f32_16x16x32_bf16 v[28:31], v[64:67], v[116:119], v[28:31]
    v_mfma_f32_16x16x32_bf16 v[32:35], v[66:69], v[116:119], v[32:35]
    ds_read_b128 v[56:59], v17 offset:144
    v_mfma_f32_16x16x32_bf16 v[36:39], v[44:47], v[116:119], v[36:39]
    s_waitcnt lgkmcnt(4)
    v_mfma_f32_16x16x32_bf16 v[40:43], v[46:49], v[116:119], v[40:43]
    ds_read_b128 v[108:111], v18 offset:160
    v_mfma_f32_16x16x32_bf16 v[28:31], v[44:47], v[96:99], v[28:31]
    v_mfma_f32_16x16x32_bf16 v[32:35], v[46:49], v[96:99], v[32:35]
    ds_read_b128 v[60:63], v17 offset:160
    v_mfma_f32_16x16x32_bf16 v[36:39], v[48:51], v[96:99], v[36:39]
    s_waitcnt lgkmcnt(4)
    v_mfma_f32_16x16x32_bf16 v[40:43], v[50:53], v[96:99], v[40:43]
    ds_read_b128 v[112:115], v18 offset:176
    v_mfma_f32_16x16x32_bf16 v[28:31], v[48:51], v[100:103], v[28:31]
    v_mfma_f32_16x16x32_bf16 v[32:35], v[50:53], v[100:103], v[32:35]
    ds_read_b128 v[64:67], v17 offset:176
    v_mfma_f32_16x16x32_bf16 v[36:39], v[52:55], v[100:103], v[36:39]
    s_waitcnt lgkmcnt(4)
    v_mfma_f32_16x16x32_bf16 v[40:43], v[54:57], v[100:103], v[40:43]
    ds_read_b128 v[116:119], v18 offset:192
    v_mfma_f32_16x16x32_bf16 v[28:31], v[52:55], v[104:107], v[28:31]
    v_mfma_f32_16x16x32_bf16 v[32:35], v[54:57], v[104:107], v[32:35]
    ds_read_b128 v[44:47], v17 offset:192
    ds_read_b64 v[68:69], v17 offset:192
    v_mfma_f32_16x16x32_bf16 v[36:39], v[56:59], v[104:107], v[36:39]
    s_waitcnt lgkmcnt(5)
    v_mfma_f32_16x16x32_bf16 v[40:43], v[58:61], v[104:107], v[40:43]
    ds_read_b128 v[96:99], v18 offset:208
    v_mfma_f32_16x16x32_bf16 v[28:31], v[56:59], v[108:111], v[28:31]
    v_mfma_f32_16x16x32_bf16 v[32:35], v[58:61], v[108:111], v[32:35]
    ds_read_b128 v[48:51], v17 offset:208
    v_mfma_f32_16x16x32_bf16 v[36:39], v[60:63], v[108:111], v[36:39]
    s_waitcnt lgkmcnt(5)
    v_mfma_f32_16x16x32_bf16 v[40:43], v[62:65], v[108:111], v[40:43]
    ds_read_b128 v[100:103], v18 offset:224
    v_mfma_f32_16x16x32_bf16 v[28:31], v[60:63], v[112:115], v[28:31]
    v_mfma_f32_16x16x32_bf16 v[32:35], v[62:65], v[112:115], v[32:35]
    ds_read_b128 v[52:55], v17 offset:224
    v_mfma_f32_16x16x32_bf16 v[36:39], v[64:67], v[112:115], v[36:39]
    s_waitcnt lgkmcnt(4)
    v_mfma_f32_16x16x32_bf16 v[40:43], v[66:69], v[112:115], v[40:43]
    ds_read_b128 v[104:107], v18 offset:240
    v_mfma_f32_16x16x32_bf16 v[28:31], v[64:67], v[116:119], v[28:31]
    v_mfma_f32_16x16x32_bf16 v[32:35], v[66:69], v[116:119], v[32:35]
    ds_read_b128 v[56:59], v17 offset:240
    v_mfma_f32_16x16x32_bf16 v[36:39], v[44:47], v[116:119], v[36:39]
    s_waitcnt lgkmcnt(4)
    v_mfma_f32_16x16x32_bf16 v[40:43], v[46:49], v[116:119], v[40:43]
    ds_read_b128 v[108:111], v18 offset:256
    v_mfma_f32_16x16x32_bf16 v[28:31], v[44:47], v[96:99], v[28:31]
    v_mfma_f32_16x16x32_bf16 v[32:35], v[46:49], v[96:99], v[32:35]
    ds_read_b128 v[60:63], v17 offset:256
    v_mfma_f32_16x16x32_bf16 v[36:39], v[48:51], v[96:99], v[36:39]
    s_waitcnt lgkmcnt(4)
    v_mfma_f32_16x16x32_bf16 v[40:43], v[50:53], v[96:99], v[40:43]
    ds_read_b128 v[112:115], v18 offset:288
    v_mfma_f32_16x16x32_bf16 v[28:31], v[48:51], v[100:103], v[28:31]
    v_mfma_f32_16x16x32_bf16 v[32:35], v[50:53], v[100:103], v[32:35]
    ds_read_b128 v[64:67], v17 offset:272
    v_mfma_f32_16x16x32_bf16 v[36:39], v[52:55], v[100:103], v[36:39]
    s_waitcnt lgkmcnt(4)
    v_mfma_f32_16x16x32_bf16 v[40:43], v[54:57], v[100:103], v[40:43]
    ds_read_b128 v[116:119], v18 offset:304
    v_mfma_f32_16x16x32_bf16 v[28:31], v[52:55], v[104:107], v[28:31]
    v_mfma_f32_16x16x32_bf16 v[32:35], v[54:57], v[104:107], v[32:35]
    ds_read_b128 v[44:47], v17 offset:288
    ds_read_b64 v[68:69], v17 offset:288
    v_mfma_f32_16x16x32_bf16 v[36:39], v[56:59], v[104:107], v[36:39]
    s_waitcnt lgkmcnt(5)
    v_mfma_f32_16x16x32_bf16 v[40:43], v[58:61], v[104:107], v[40:43]
    ds_read_b128 v[96:99], v18 offset:320
    v_mfma_f32_16x16x32_bf16 v[28:31], v[56:59], v[108:111], v[28:31]
    v_mfma_f32_16x16x32_bf16 v[32:35], v[58:61], v[108:111], v[32:35]
    ds_read_b128 v[48:51], v17 offset:304
    v_mfma_f32_16x16x32_bf16 v[36:39], v[60:63], v[108:111], v[36:39]
    s_waitcnt lgkmcnt(5)
    v_mfma_f32_16x16x32_bf16 v[40:43], v[62:65], v[108:111], v[40:43]
    ds_read_b128 v[100:103], v18 offset:336
    v_mfma_f32_16x16x32_bf16 v[28:31], v[60:63], v[112:115], v[28:31]
    v_mfma_f32_16x16x32_bf16 v[32:35], v[62:65], v[112:115], v[32:35]
    ds_read_b128 v[52:55], v17 offset:320
    s_cmp_eq_u32 s12, 0
    s_cbranch_scc1 LB2r
    v_mfma_f32_16x16x32_bf16 v[36:39], v[64:67], v[112:115], v[36:39]
    s_waitcnt lgkmcnt(4)
    v_mfma_f32_16x16x32_bf16 v[40:43], v[66:69], v[112:115], v[40:43]
    ds_read_b128 v[104:107], v18 offset:352
    v_mfma_f32_16x16x32_bf16 v[28:31], v[64:67], v[116:119], v[28:31]
    v_mfma_f32_16x16x32_bf16 v[32:35], v[66:69], v[116:119], v[32:35]
    ds_read_b128 v[56:59], v17 offset:336
    v_mfma_f32_16x16x32_bf16 v[36:39], v[44:47], v[116:119], v[36:39]
    s_waitcnt lgkmcnt(4)
    v_mfma_f32_16x16x32_bf16 v[40:43], v[46:49], v[116:119], v[40:43]
    ds_read_b128 v[108:111], v18 offset:368
    v_mfma_f32_16x16x32_bf16 v[28:31], v[44:47], v[96:99], v[28:31]
    v_mfma_f32_16x16x32_bf16 v[32:35], v[46:49], v[96:99], v[32:35]
    ds_read_b128 v[60:63], v17 offset:352
    v_mfma_f32_16x16x32_bf16 v[36:39], v[48:51], v[96:99], v[36:39]
    s_waitcnt lgkmcnt(4)
    v_mfma_f32_16x16x32_bf16 v[40:43], v[50:53], v[96:99], v[40:43]
    ds_read_b128 v[112:115], v18 offset:384
    v_mfma_f32_16x16x32_bf16 v[28:31], v[48:51], v[100:103], v[28:31]
    v_mfma_f32_16x16x32_bf16 v[32:35], v[50:53], v[100:103], v[32:35]
    ds_read_b128 v[64:67], v17 offset:368
    v_mfma_f32_16x16x32_bf16 v[36:39], v[52:55], v[100:103], v[36:39]
    s_waitcnt lgkmcnt(4)
    v_mfma_f32_16x16x32_bf16 v[40:43], v[54:57], v[100:103], v[40:43]
    ds_read_b128 v[116:119], v18 offset:400
    v_mfma_f32_16x16x32_bf16 v[28:31], v[52:55], v[104:107], v[28:31]
    v_mfma_f32_16x16x32_bf16 v[32:35], v[54:57], v[104:107], v[32:35]
    ds_read_b128 v[44:47], v17 offset:384
    ds_read_b64 v[68:69], v17 offset:384
    v_mfma_f32_16x16x32_bf16 v[36:39], v[56:59], v[104:107], v[36:39]
    s_waitcnt lgkmcnt(5)
    v_mfma_f32_16x16x32_bf16 v[40:43], v[58:61], v[104:107], v[40:43]
    ds_read_b128 v[96:99], v18 offset:432
    v_mfma_f32_16x16x32_bf16 v[28:31], v[56:59], v[108:111], v[28:31]
    v_mfma_f32_16x16x32_bf16 v[32:35], v[58:61], v[108:111], v[32:35]
    ds_read_b128 v[48:51], v17 offset:400
    v_mfma_f32_16x16x32_bf16 v[36:39], v[60:63], v[108:111], v[36:39]
    s_waitcnt lgkmcnt(5)
    v_mfma_f32_16x16x32_bf16 v[40:43], v[62:65], v[108:111], v[40:43]
    ds_read_b128 v[100:103], v18 offset:448
    v_mfma_f32_16x16x32_bf16 v[28:31], v[60:63], v[112:115], v[28:31]
    v_mfma_f32_16x16x32_bf16 v[32:35], v[62:65], v[112:115], v[32:35]
    ds_read_b128 v[52:55], v17 offset:416
    v_mfma_f32_16x16x32_bf16 v[36:39], v[64:67], v[112:115], v[36:39]
    s_waitcnt lgkmcnt(4)
    v_mfma_f32_16x16x32_bf16 v[40:43], v[66:69], v[112:115], v[40:43]
    ds_read_b128 v[104:107], v18 offset:464
    v_mfma_f32_16x16x32_bf16 v[28:31], v[64:67], v[116:119], v[28:31]
    v_mfma_f32_16x16x32_bf16 v[32:35], v[66:69], v[116:119], v[32:35]
    ds_read_b128 v[56:59], v17 offset:432
    v_mfma_f32_16x16x32_bf16 v[36:39], v[44:47], v[116:119], v[36:39]
    s_waitcnt lgkmcnt(4)
    v_mfma_f32_16x16x32_bf16 v[40:43], v[46:49], v[116:119], v[40:43]
    ds_read_b128 v[108:111], v18 offset:480
    v_mfma_f32_16x16x32_bf16 v[28:31], v[44:47], v[96:99], v[28:31]
    v_mfma_f32_16x16x32_bf16 v[32:35], v[46:49], v[96:99], v[32:35]
    ds_read_b128 v[60:63], v17 offset:448
    v_mfma_f32_16x16x32_bf16 v[36:39], v[48:51], v[96:99], v[36:39]
    s_waitcnt lgkmcnt(4)
    v_mfma_f32_16x16x32_bf16 v[40:43], v[50:53], v[96:99], v[40:43]
    ds_read_b128 v[112:115], v18 offset:496
    v_mfma_f32_16x16x32_bf16 v[28:31], v[48:51], v[100:103], v[28:31]
    v_mfma_f32_16x16x32_bf16 v[32:35], v[50:53], v[100:103], v[32:35]
    ds_read_b128 v[64:67], v17 offset:464
    v_mfma_f32_16x16x32_bf16 v[36:39], v[52:55], v[100:103], v[36:39]
    s_waitcnt lgkmcnt(4)
    v_mfma_f32_16x16x32_bf16 v[40:43], v[54:57], v[100:103], v[40:43]
    ds_read_b128 v[116:119], v18 offset:512
    v_mfma_f32_16x16x32_bf16 v[28:31], v[52:55], v[104:107], v[28:31]
    v_mfma_f32_16x16x32_bf16 v[32:35], v[54:57], v[104:107], v[32:35]
    ds_read_b128 v[44:47], v17 offset:480
    ds_read_b64 v[68:69], v17 offset:480
    v_mfma_f32_16x16x32_bf16 v[36:39], v[56:59], v[104:107], v[36:39]
    s_waitcnt lgkmcnt(5)
    v_mfma_f32_16x16x32_bf16 v[40:43], v[58:61], v[104:107], v[40:43]
    ds_read_b128 v[96:99], v18 offset:528
    v_mfma_f32_16x16x32_bf16 v[28:31], v[56:59], v[108:111], v[28:31]
    v_mfma_f32_16x16x32_bf16 v[32:35], v[58:61], v[108:111], v[32:35]
    ds_read_b128 v[48:51], v17 offset:496
    v_mfma_f32_16x16x32_bf16 v[36:39], v[60:63], v[108:111], v[36:39]
    s_waitcnt lgkmcnt(5)
    v_mfma_f32_16x16x32_bf16 v[40:43], v[62:65], v[108:111], v[40:43]
    ds_read_b128 v[100:103], v18 offset:544
    v_mfma_f32_16x16x32_bf16 v[28:31], v[60:63], v[112:115], v[28:31]
    v_mfma_f32_16x16x32_bf16 v[32:35], v[62:65], v[112:115], v[32:35]
    ds_read_b128 v[52:55], v17 offset:512
    v_mfma_f32_16x16x32_bf16 v[36:39], v[64:67], v[112:115], v[36:39]
    s_waitcnt lgkmcnt(4)
    v_mfma_f32_16x16x32_bf16 v[40:43], v[66:69], v[112:115], v[40:43]
    ds_read_b128 v[104:107], v18 offset:576
    v_mfma_f32_16x16x32_bf16 v[28:31], v[64:67], v[116:119], v[28:31]
    v_mfma_f32_16x16x32_bf16 v[32:35], v[66:69], v[116:119], v[32:35]
    ds_read_b128 v[56:59], v17 offset:528
    v_mfma_f32_16x16x32_bf16 v[36:39], v[44:47], v[116:119], v[36:39]
    s_waitcnt lgkmcnt(4)
    v_mfma_f32_16x16x32_bf16 v[40:43], v[46:49], v[116:119], v[40:43]
    v_mfma_f32_16x16x32_bf16 v[28:31], v[44:47], v[96:99], v[28:31]
    v_mfma_f32_16x16x32_bf16 v[32:35], v[46:49], v[96:99], v[32:35]
    v_mfma_f32_16x16x32_bf16 v[36:39], v[48:51], v[96:99], v[36:39]
    s_waitcnt lgkmcnt(2)
    v_mfma_f32_16x16x32_bf16 v[40:43], v[50:53], v[96:99], v[40:43]
    v_mfma_f32_16x16x32_bf16 v[28:31], v[48:51], v[100:103], v[28:31]
    v_mfma_f32_16x16x32_bf16 v[32:35], v[50:53], v[100:103], v[32:35]
    v_mfma_f32_16x16x32_bf16 v[36:39], v[52:55], v[100:103], v[36:39]
    s_waitcnt lgkmcnt(0)
    v_mfma_f32_16x16x32_bf16 v[40:43], v[54:57], v[100:103], v[40:43]
    v_mfma_f32_16x16x32_bf16 v[28:31], v[52:55], v[104:107], v[28:31]
    v_mfma_f32_16x16x32_bf16 v[32:35], v[54:57], v[104:107], v[32:35]
    s_nop 7
LB2r:
    s_nop 7
    v_mov_b32 v2, 1
    s_cmp_lg_u32 s11, 1
    s_cbranch_scc1 Lb254
    ds_write_b128 v21, v[28:31] offset:0
    ds_write_b128 v21, v[32:35] offset:1024
    ds_write_b128 v21, v[36:39] offset:2048
    ds_write_b128 v21, v[40:43] offset:3072
    s_waitcnt lgkmcnt(0)
    s_mov_b64 exec, 1
    ds_add_u32 v27, v2
    s_mov_b64 exec, -1
    s_branch LB2end
LB2hi:
    s_setprio 1
    ds_read_b128 v[44:47], v17 offset:0
    ds_read_b128 v[70:73], v17 offset:2048
    ds_read_b128 v[96:99], v18 offset:0
    ds_read_b128 v[48:51], v17 offset:16
    ds_read_b128 v[74:77], v17 offset:2064
    ds_read_b128 v[100:103], v18 offset:16
    ds_read_b128 v[52:55], v17 offset:32
    ds_read_b128 v[78:81], v17 offset:2080
    ds_read_b128 v[104:107], v18 offset:32
    ds_read_b128 v[56:59], v17 offset:48
    ds_read_b128 v[82:85], v17 offset:2096
    s_waitcnt lgkmcnt(8)
    v_mfma_f32_16x16x32_bf16 v[28:31], v[44:47], v[96:99], v[28:31]
    ds_read_b128 v[108:111], v18 offset:48
    s_waitcnt lgkmcnt(8)
    v_mfma_f32_16x16x32_bf16 v[32:35], v[46:49], v[96:99], v[32:35]
    ds_read_b128 v[60:63], v17 offset:64
    v_mfma_f32_16x16x32_bf16 v[36:39], v[70:73], v[96:99], v[36:39]
    s_waitcnt lgkmcnt(8)
    v_mfma_f32_16x16x32_bf16 v[40:43], v[72:75], v[96:99], v[40:43]
    ds_read_b128 v[86:89], v17 offset:2112
    s_waitcnt lgkmcnt(8)
    v_mfma_f32_16x16x32_bf16 v[28:31], v[48:51], v[100:103], v[28:31]
    ds_read_b128 v[112:115], v18 offset:64
    s_waitcnt lgkmcnt(8)
    v_mfma_f32_16x16x32_bf16 v[32:35], v[50:53], v[100:103], v[32:35]
    ds_read_b128 v[64:67], v17 offset:80
    v_mfma_f32_16x16x32_bf16 v[36:39], v[74:77], v[100:103], v[36:39]
    s_waitcnt lgkmcnt(8)
    v_mfma_f32_16x16x32_bf16 v[40:43], v[76:79], v[100:103], v[40:43]
    ds_read_b128 v[90:93], v17 offset:2128
    s_waitcnt lgkmcnt(8)
    v_mfma_f32_16x16x32_bf16 v[28:31], v[52:55], v[104:107], v[28:31]
    ds_read_b128 v[116:119], v18 offset:80
    s_waitcnt lgkmcnt(8)
    v_mfma_f32_16x16x32_bf16 v[32:35], v[54:57], v[104:107], v[32:35]
    ds_read_b128 v[44:47], v17 offset:96
    ds_read_b64 v[68:69], v17 offset:96
    v_mfma_f32_16x16x32_bf16 v[36:39], v[78:81], v[104:107], v[36:39]
    s_waitcnt lgkmcnt(9)
    v_mfma_f32_16x16x32_bf16 v[40:43], v[80:83], v[104:107], v[40:43]
    ds_read_b128 v[70:73], v17 offset:2144
    ds_read_b64 v[94:95], v17 offset:2144
    s_waitcnt lgkmcnt(10)
    v_mfma_f32_16x16x32_bf16 v[28:31], v[56:59], v[108:111], v[28:31]
    ds_read_b128 v[96:99], v18 offset:96
    s_waitcnt lgkmcnt(10)
    v_mfma_f32_16x16x32_bf16 v[32:35], v[58:61], v[108:111], v[32:35]
    ds_read_b128 v[48:51], v17 offset:112
    v_mfma_f32_16x16x32_bf16 v[36:39], v[82:85], v[108:111], v[36:39]
    s_waitcnt lgkmcnt(10)
    v_mfma_f32_16x16x32_bf16 v[40:43], v[84:87], v[108:111], v[40:43]
    ds_read_b128 v[74:77], v17 offset:2160
    s_waitcnt lgkmcnt(10)
    v_mfma_f32_16x16x32_bf16 v[28:31], v[60:63], v[112:115], v[28:31]
    ds_read_b128 v[100:103], v19 offset:112
    s_waitcnt lgkmcnt(10)
    v_mfma_f32_16x16x32_bf16 v[32:35], v[62:65], v[112:115], v[32:35]
    ds_read_b128 v[52:55], v17 offset:128
    v_mfma_f32_16x16x32_bf16 v[36:39], v[86:89], v[112:115], v[36:39]
    s_waitcnt lgkmcnt(10)
    v_mfma_f32_16x16x32_bf16 v[40:43], v[88:91], v[112:115], v[40:43]
    ds_read_b128 v[78:81], v17 offset:2176
    s_waitcnt lgkmcnt(10)
    v_mfma_f32_16x16x32_bf16 v[28:31], v[64:67], v[116:119], v[28:31]
    ds_read_b128 v[104:107], v18 offset:144
    s_waitcnt lgkmcnt(9)
    v_mfma_f32_16x16x32_bf16 v[32:35], v[66:69], v[116:119], v[32:35]
    ds_read_b128 v[56:59], v17 offset:144
    v_mfma_f32_16x16x32_bf16 v[36:39], v[90:93], v[116:119], v[36:39]
    s_waitcnt lgkmcnt(8)
    v_mfma_f32_16x16x32_bf16 v[40:43], v[92:95], v[116:119], v[40:43]
    ds_read_b128 v[82:85], v17 offset:2192
    s_waitcnt lgkmcnt(8)
    v_mfma_f32_16x16x32_bf16 v[28:31], v[44:47], v[96:99], v[28:31]
    ds_read_b128 v[108:111], v18 offset:160
    s_waitcnt lgkmcnt(8)
    v_mfma_f32_16x16x32_bf16 v[32:35], v[46:49], v[96:99], v[32:35]
    ds_read_b128 v[60:63], v17 offset:160
    v_mfma_f32_16x16x32_bf16 v[36:39], v[70:73], v[96:99], v[36:39]
    s_waitcnt lgkmcnt(8)
    v_mfma_f32_16x16x32_bf16 v[40:43], v[72:75], v[96:99], v[40:43]
    ds_read_b128 v[86:89], v17 offset:2208
    s_waitcnt lgkmcnt(8)
    v_mfma_f32_16x16x32_bf16 v[28:31], v[48:51], v[100:103], v[28:31]
    ds_read_b128 v[112:115], v18 offset:176
    s_waitcnt lgkmcnt(8)
    v_mfma_f32_16x16x32_bf16 v[32:35], v[50:53], v[100:103], v[32:35]
    ds_read_b128 v[64:67], v17 offset:176
    v_mfma_f32_16x16x32_bf16 v[36:39], v[74:77], v[100:103], v[36:39]
    s_waitcnt lgkmcnt(8)
    v_mfma_f32_16x16x32_bf16 v[40:43], v[76:79], v[100:103], v[40:43]
    ds_read_b128 v[90:93], v17 offset:2224
    s_waitcnt lgkmcnt(8)
    v_mfma_f32_16x16x32_bf16 v[28:31], v[52:55], v[104:107], v[28:31]
    ds_read_b128 v[116:119], v18 offset:192
    s_waitcnt lgkmcnt(8)
    v_mfma_f32_16x16x32_bf16 v[32:35], v[54:57], v[104:107], v[32:35]
    ds_read_b128 v[44:47], v17 offset:192
    ds_read_b64 v[68:69], v17 offset:192
    v_mfma_f32_16x16x32_bf16 v[36:39], v[78:81], v[104:107], v[36:39]
    s_waitcnt lgkmcnt(9)
    v_mfma_f32_16x16x32_bf16 v[40:43], v[80:83], v[104:107], v[40:43]
    ds_read_b128 v[70:73], v17 offset:2240
    ds_read_b64 v[94:95], v17 offset:2240
    s_waitcnt lgkmcnt(10)
    v_mfma_f32_16x16x32_bf16 v[28:31], v[56:59], v[108:111], v[28:31]
    ds_read_b128 v[96:99], v18 offset:208
    s_waitcnt lgkmcnt(10)
    v_mfma_f32_16x16x32_bf16 v[32:35], v[58:61], v[108:111], v[32:35]
    ds_read_b128 v[48:51], v17 offset:208
    v_mfma_f32_16x16x32_bf16 v[36:39], v[82:85], v[108:111], v[36:39]
    s_waitcnt lgkmcnt(10)
    v_mfma_f32_16x16x32_bf16 v[40:43], v[84:87], v[108:111], v[40:43]
    ds_read_b128 v[74:77], v17 offset:2256
    s_waitcnt lgkmcnt(10)
    v_mfma_f32_16x16x32_bf16 v[28:31], v[60:63], v[112:115], v[28:31]
    ds_read_b128 v[100:103], v18 offset:224
    s_waitcnt lgkmcnt(10)
    v_mfma_f32_16x16x32_bf16 v[32:35], v[62:65], v[112:115], v[32:35]
    ds_read_b128 v[52:55], v17 offset:224
    v_mfma_f32_16x16x32_bf16 v[36:39], v[86:89], v[112:115], v[36:39]
    s_waitcnt lgkmcnt(10)
    v_mfma_f32_16x16x32_bf16 v[40:43], v[88:91], v[112:115], v[40:43]
    ds_read_b128 v[78:81], v17 offset:2272
    s_waitcnt lgkmcnt(10)
    v_mfma_f32_16x16x32_bf16 v[28:31], v[64:67], v[116:119], v[28:31]
    ds_read_b128 v[104:107], v18 offset:240
    s_waitcnt lgkmcnt(9)
    v_mfma_f32_16x16x32_bf16 v[32:35], v[66:69], v[116:119], v[32:35]
    ds_read_b128 v[56:59], v17 offset:240
    v_mfma_f32_16x16x32_bf16 v[36:39], v[90:93], v[116:119], v[36:39]
    s_waitcnt lgkmcnt(8)
    v_mfma_f32_16x16x32_bf16 v[40:43], v[92:95], v[116:119], v[40:43]
    ds_read_b128 v[82:85], v17 offset:2288
    s_waitcnt lgkmcnt(8)
    v_mfma_f32_16x16x32_bf16 v[28:31], v[44:47], v[96:99], v[28:31]
    ds_read_b128 v[108:111], v19 offset:256
    s_waitcnt lgkmcnt(8)
    v_mfma_f32_16x16x32_bf16 v[32:35], v[46:49], v[96:99], v[32:35]
    ds_read_b128 v[60:63], v17 offset:256
    v_mfma_f32_16x16x32_bf16 v[36:39], v[70:73], v[96:99], v[36:39]
    s_waitcnt lgkmcnt(8)
    v_mfma_f32_16x16x32_bf16 v[40:43], v[72:75], v[96:99], v[40:43]
    ds_read_b128 v[86:89], v17 offset:2304
    s_waitcnt lgkmcnt(8)
    v_mfma_f32_16x16x32_bf16 v[28:31], v[48:51], v[100:103], v[28:31]
    s_waitcnt lgkmcnt(7)
    v_mfma_f32_16x16x32_bf16 v[32:35], v[50:53], v[100:103], v[32:35]
    v_mfma_f32_16x16x32_bf16 v[36:39], v[74:77], v[100:103], v[36:39]
    s_waitcnt lgkmcnt(6)
    v_mfma_f32_16x16x32_bf16 v[40:43], v[76:79], v[100:103], v[40:43]
    s_waitcnt lgkmcnt(5)
    v_mfma_f32_16x16x32_bf16 v[28:31], v[52:55], v[104:107], v[28:31]
    s_waitcnt lgkmcnt(4)
    v_mfma_f32_16x16x32_bf16 v[32:35], v[54:57], v[104:107], v[32:35]
    v_mfma_f32_16x16x32_bf16 v[36:39], v[78:81], v[104:107], v[36:39]
    s_waitcnt lgkmcnt(3)
    v_mfma_f32_16x16x32_bf16 v[40:43], v[80:83], v[104:107], v[40:43]
    s_waitcnt lgkmcnt(2)
    v_mfma_f32_16x16x32_bf16 v[28:31], v[56:59], v[108:111], v[28:31]
    s_waitcnt lgkmcnt(1)
    v_mfma_f32_16x16x32_bf16 v[32:35], v[58:61], v[108:111], v[32:35]
    v_mfma_f32_16x16x32_bf16 v[36:39], v[82:85], v[108:111], v[36:39]
    s_waitcnt lgkmcnt(0)
    v_mfma_f32_16x16x32_bf16 v[40:43], v[84:87], v[108:111], v[40:43]
    v_mov_b32 v2, 1
    s_nop 1
    ds_write_b128 v21, v[28:31] offset:4096
    s_nop 0
    ds_write_b128 v21, v[32:35] offset:4608
    ds_write_b128 v21, v[36:39] offset:6144
    s_nop 0
    ds_write_b128 v21, v[40:43] offset:6656
    s_waitcnt lgkmcnt(0)
    s_mov_b64 exec, 1
    ds_add_u32 v27, v2
    ds_add_u32 v27, v2 offset:4
    s_mov_b64 exec, -1
    s_branch LB2end
Lb254:
    s_lshl_b32 s8, s11, 1
    v_add_u32 v1, s8, v27
    s_add_u32 s14, s12, 1
    s_nop 0
Lb255:
    ds_read_b32 v2, v1
    s_waitcnt lgkmcnt(0)
    v_readfirstlane_b32 s40, v2
    s_cmp_lt_u32 s40, s14
    s_cbranch_scc1 Lb255
    ds_read_b128 v[44:47], v22 offset:0
    ds_read_b128 v[48:51], v22 offset:512
    ds_read_b128 v[52:55], v22 offset:1024
    ds_read_b128 v[56:59], v22 offset:1536
    s_cmp_eq_u32 s12, 0
    s_cbranch_scc1 Lb256
    ds_read_b128 v[96:99], v21 offset:0
    ds_read_b128 v[100:103], v21 offset:1024
    ds_read_b128 v[104:107], v21 offset:2048
    ds_read_b128 v[108:111], v21 offset:3072
    s_waitcnt lgkmcnt(3)
    v_add_f32 v28, v28, v96
    v_add_f32 v29, v29, v97
    v_add_f32 v30, v30, v98
    v_add_f32 v31, v31, v99
    s_waitcnt lgkmcnt(2)
    v_add_f32 v32, v32, v100
    v_add_f32 v33, v33, v101
    v_add_f32 v34, v34, v102
    v_add_f32 v35, v35, v103
    s_waitcnt lgkmcnt(1)
    v_add_f32 v36, v36, v104
    v_add_f32 v37, v37, v105
    v_add_f32 v38, v38, v106
    v_add_f32 v39, v39, v107
    s_waitcnt lgkmcnt(0)
    v_add_f32 v40, v40, v108
    v_add_f32 v41, v41, v109
    v_add_f32 v42, v42, v110
    v_add_f32 v43, v43, v111
    s_nop 1
Lb256:
    s_mov_b32 exec_lo, 4278255360
    s_mov_b32 exec_hi, 4278255360
    s_waitcnt lgkmcnt(0)
    v_add_f32 v28, v28, v44
    v_add_f32 v29, v29, v45
    v_add_f32 v30, v30, v46
    v_add_f32 v31, v31, v47
    v_add_f32 v32, v32, v48
    v_add_f32 v33, v33, v49
    v_add_f32 v34, v34, v50
    v_add_f32 v35, v35, v51
    v_add_f32 v36, v36, v52
    v_add_f32 v37, v37, v53
    v_add_f32 v38, v38, v54
    v_add_f32 v39, v39, v55
    v_add_f32 v40, v40, v56
    v_add_f32 v41, v41, v57
    v_add_f32 v42, v42, v58
    v_add_f32 v43, v43, v59
    s_mov_b64 exec, -1
    v_cvt_pk_bf16_f32 v4, v43, v42
    v_or_b32 v4, 1, v4
    v_cvt_pk_bf16_f32 v5, v41, v40
    v_and_b32 v5, -2, v5
    v_cvt_pk_bf16_f32 v6, v39, v38
    v_or_b32 v6, 1, v6
    v_cvt_pk_bf16_f32 v7, v37, v36
    v_and_b32 v7, -2, v7
    ds_write_b128 v23, v[4:7]
    v_cvt_pk_bf16_f32 v8, v35, v34
    v_or_b32 v8, 1, v8
    v_cvt_pk_bf16_f32 v9, v33, v32
    v_and_b32 v9, -2, v9
    v_cvt_pk_bf16_f32 v10, v31, v30
    v_or_b32 v10, 1, v10
    v_cvt_pk_bf16_f32 v11, v29, v28
    v_and_b32 v11, -2, v11
    ds_write_b128 v24, v[8:11]
    ds_read_b128 v[96:99], v25
    ds_read_b128 v[100:103], v25 offset:1024
    s_waitcnt lgkmcnt(1)
    global_store_dwordx4 v26, v[96:99], s[38:39] sc1
    s_waitcnt lgkmcnt(0)
    global_store_dwordx4 v26, v[100:103], s[38:39] offset:1024 sc1
    s_cmp_eq_u32 s5, 0
    s_cbranch_scc1 LB2end
    v_mov_b32 v1, 92
    v_mov_b32 v2, 1
    s_waitcnt vmcnt(0) lgkmcnt(0)
    s_mov_b64 exec, 1
    ds_add_u32 v1, v2
    s_mov_b64 exec, -1
LB2end:
    s_setprio 0
    s_mov_b32 s62, 0
    s_waitcnt lgkmcnt(0)
    s_lshr_b32 s99, s99, 5
    s_cbranch_scc1 LB2p
    s_cmp_eq_u32 s5, 0
    s_cbranch_scc1 LA3
    s_cmp_eq_u32 s98, 8
    s_cbranch_scc1 LB3
    s_mov_b32 s44, s22
    s_and_b32 s45, s23, 65535
    s_mov_b32 s46, 2621440
    s_mov_b32 s47, 131072
    v_mul_u32_u24 v1, 26, v0
    v_lshrrev_b32 v1, 8, v1
    v_mul_u32_u24 v2, 1120, v1
    v_lshl_add_u32 v2, v0, 4, v2
    s_lshl_b32 s8, s6, 3
    s_add_u32 s8, s8, s98
    s_mul_i32 s8, s8, 20480
    s_mul_i32 s14, s4, 160
    s_add_u32 s8, s8, s14
    s_mul_i32 s14, s98, 2592
    s_mov_b32 exec_hi, 255
    s_add_u32 m0, s14, 138256
    s_nop 0
    buffer_load_dwordx4 v2, s[44:47], s8 offen lds
    s_addk_i32 s8, 5120
    s_add_u32 m0, s14, 138896
    s_nop 0
    buffer_load_dwordx4 v2, s[44:47], s8 offen lds
    s_addk_i32 s8, 5120
    s_add_u32 m0, s14, 139552
    s_nop 0
    buffer_load_dwordx4 v2, s[44:47], s8 offen lds
    s_addk_i32 s8, 5120
    s_add_u32 m0, s14, 140192
    s_nop 0
    buffer_load_dwordx4 v2, s[44:47], s8 offen lds
    s_mov_b64 exec, -1
    v_mov_b32 v1, 36
    v_mov_b32 v2, 1
    s_waitcnt vmcnt(0) lgkmcnt(0)
    s_mov_b64 exec, 1
    ds_add_u32 v1, v2
    s_mov_b64 exec, -1
    s_branch LB3
LA3:
    s_mul_i32 s8, s7, 20608
    s_and_b32 s12, s3, 1
    s_mul_i32 s13, s12, 1280
    s_lshr_b32 s14, s3, 1
    s_lshl_b32 s14, s14, 7
    s_add_u32 s13, s13, s14
    s_add_u32 s13, s13, s8
    v_lshrrev_b32 v1, 4, v0
    v_mul_u32_u24 v4, 2432, v1
    v_lshl_add_u32 v4, v0, 3, v4
    v_add_u32 v4, s13, v4
    v_add_u32 v5, 10240, v4
    s_lshl2_add_u32 s8, s12, s8
    s_add_u32 s8, s8, 20480
    v_lshl_add_u32 v6, v1, 3, s8
    v_mov_b32 v1, 4
    s_nop 1
Lbl57:
    ds_read_b32 v2, v1
    s_waitcnt lgkmcnt(0)
    v_readfirstlane_b32 s40, v2
    s_cmp_lt_u32 s40, 8
    s_cbranch_scc1 Lbl57
Lbd58:
    s_lshl_b32 s9, s3, 7
    s_add_u32 s9, s9, s7
    s_mul_i32 s10, s9, 2560
    s_mul_i32 s11, s3, 3072
    s_add_u32 s11, s11, 139264
    v_lshlrev_b32 v1, 4, v0
    v_add_u32 v13, s10, v1
    v_add_u32 v14, 2620032, v13
    v_cmp_gt_u32 vcc, 24, v0
    s_nop 1
    v_cndmask_b32 v14, v14, v13, vcc
    v_min_u32 v1, 624, v1
    v_add_u32 v1, 2620032, v1
    v_add_u32 v15, s10, v1
    v_lshrrev_b32 v3, 4, v0
    v_and_b32 v124, 7, v0
    v_cvt_f32_u32 v124, v124
    v_mul_f32 v124, 0x3e000000, v124
    v_bfe_u32 v125, v0, 3, 1
    v_lshrrev_b32 v126, 5, v0
    v_lshl_add_u32 v125, v125, 10, s9
    v_mul_u32_u24 v125, v125, v126
    v_cvt_f32_u32 v125, v125
    v_mul_f32 v125, 0x3a000000, v125
    v_lshlrev_b32 v131, 27, v0
    v_and_b32 v131, 2147483648, v131
    v_xor_b32 v125, v125, v131
    v_bfe_u32 v126, v0, 4, 1
    v_lshlrev_b32 v126, 2, v126
    v_cvt_f32_u32 v126, v126
    v_fma_f32 v127, v124, v126, v125
    v_lshrrev_b32 v126, 16, v131
    v_or_b32 v126, v126, v131
    v_add_f32 v128, v127, v124
    v_add_f32 v129, v128, v124
    v_add_f32 v130, v129, v124
    v_cos_f32 v131, v127
    v_sin_f32 v135, v127
    v_cos_f32 v132, v128
    v_sin_f32 v136, v128
    v_cos_f32 v133, v129
    v_sin_f32 v137, v129
    v_cos_f32 v134, v130
    v_sin_f32 v138, v130
    v_mul_f32 v131, 0x35cccccd, v131
    v_mul_f32 v132, 0x35cccccd, v132
    v_mul_f32 v133, 0x35cccccd, v133
    v_mul_f32 v134, 0x35cccccd, v134
    v_mul_f32 v135, 0x35cccccd, v135
    v_mul_f32 v136, 0x35cccccd, v136
    v_mul_f32 v137, 0x35cccccd, v137
    v_mul_f32 v138, 0x35cccccd, v138
    v_cvt_pk_bf16_f32 v16, v131, v132
    v_cvt_pk_bf16_f32 v20, v135, v136
    v_cvt_pk_bf16_f32 v18, -v135, -v136
    v_xor_b32 v18, v126, v18
    v_xor_b32 v22, v126, v16
    v_cvt_pk_bf16_f32 v17, v133, v134
    v_cvt_pk_bf16_f32 v21, v137, v138
    v_cvt_pk_bf16_f32 v19, -v137, -v138
    v_xor_b32 v19, v126, v19
    v_xor_b32 v23, v126, v17
    v_and_b32 v1, 15, v0
    v_cvt_f32_u32 v1, v1
    v_mul_f32 v1, 0x3d800000, v1
    v_lshlrev_b32 v2, 2, v3
    v_cvt_f32_u32 v2, v2
    v_mul_f32 v124, v1, v2
    v_add_f32 v125, v124, v1
    v_add_f32 v126, v125, v1
    v_add_f32 v127, v126, v1
    v_cos_f32 v128, v124
    v_sin_f32 v132, v124
    v_cos_f32 v129, v125
    v_sin_f32 v133, v125
    v_cos_f32 v130, v126
    v_sin_f32 v134, v126
    v_cos_f32 v131, v127
    v_sin_f32 v135, v127
    v_cvt_pk_bf16_f32 v96, v128, v129
    v_cvt_pk_bf16_f32 v98, -v132, -v133
    v_cvt_pk_bf16_f32 v97, v130, v131
    v_cvt_pk_bf16_f32 v99, -v134, -v135
    v_and_b32 v1, 7, v0
    v_lshl_add_u32 v1, v1, 7, s7
    v_and_b32 v2, 8, v0
    v_cmp_eq_u32 vcc, 0, v2
    v_add_u32 v2, 0, v3
    v_mul_u32_u24 v2, v2, v1
    v_cvt_f32_u32 v2, v2
    v_mul_f32 v2, 0x3a800000, v2
    v_cos_f32 v112, v2
    v_sin_f32 v113, v2
    s_nop 0
    v_cvt_pk_bf16_f32 v114, v112, -v113
    v_cvt_pk_bf16_f32 v115, v113, v112
    v_cndmask_b32 v24, 0, v114, vcc
    v_cndmask_b32 v25, v114, 0, vcc
    v_cndmask_b32 v28, 0, v115, vcc
    v_cndmask_b32 v29, v115, 0, vcc
    v_add_u32 v2, 4, v3
    v_mul_u32_u24 v2, v2, v1
    v_cvt_f32_u32 v2, v2
    v_mul_f32 v2, 0x3a800000, v2
    v_cos_f32 v112, v2
    v_sin_f32 v113, v2
    s_nop 0
    v_cvt_pk_bf16_f32 v114, v112, -v113
    v_cvt_pk_bf16_f32 v115, v113, v112
    v_cndmask_b32 v26, 0, v114, vcc
    v_cndmask_b32 v27, v114, 0, vcc
    v_cndmask_b32 v30, 0, v115, vcc
    v_cndmask_b32 v31, v115, 0, vcc
    v_and_b32 v7, 7, v0
    v_mul_u32_u24 v7, 2880, v7
    v_and_b32 v1, 8, v0
    v_lshl_add_u32 v7, v1, 2, v7
    v_lshl_add_u32 v7, v3, 3, v7
    s_mul_i32 s8, s12, 1408
    s_lshr_b32 s14, s14, 1
    s_add_u32 s8, s8, s14
    s_add_u32 s8, s8, 116224
    v_add_u32 v7, s8, v7
    v_and_b32 v112, 28, v0
    v_lshrrev_b32 v113, 5, v0
    v_mul_u32_u24 v113, 1408, v113
    s_mul_i32 s8, s3, 2880
    s_add_u32 s8, s8, 116224
    v_add_u32 v113, s8, v113
    v_cmp_gt_u32 vcc, 16, v112
    v_bfe_u32 v1, v0, 1, 1
    v_add3_u32 v1, v1, v112, 0
    v_sub_u32 v2, 31, v1
    v_min_u32 v1, v1, v2
    v_mul_u32_u24 v8, 40, v1
    v_add_u32 v2, 16, v8
    v_cndmask_b32 v8, v2, v8, vcc
    v_and_b32 v1, 1, v0
    v_lshl_add_u32 v8, v1, 3, v8
    v_add_u32 v8, v8, v113
    v_bfe_u32 v1, v0, 1, 1
    v_add3_u32 v1, v1, v112, 2
    v_sub_u32 v2, 31, v1
    v_min_u32 v1, v1, v2
    v_mul_u32_u24 v9, 40, v1
    v_add_u32 v2, 16, v9
    v_cndmask_b32 v9, v2, v9, vcc
    v_and_b32 v1, 1, v0
    v_lshl_add_u32 v9, v1, 3, v9
    v_add_u32 v9, v9, v113
    v_and_b32 v1, 31, v0
    v_mul_u32_u24 v10, 40, v1
    v_add_u32 v10, 32, v10
    v_mov_b32 v2, 648
    v_cndmask_b32 v10, v2, v10, vcc
    v_cmp_eq_u32 vcc, 16, v1
    v_mov_b32 v2, 640
    s_nop 0
    v_cndmask_b32 v10, v10, v2, vcc
    v_add_u32 v10, v10, v113
    v_lshrrev_b32 v11, 5, v0
    v_mul_u32_u24 v11, 1408, v11
    v_and_b32 v1, 1, v3
    v_lshl_add_u32 v11, v1, 3, v11
    v_and_b32 v1, 15, v0
    v_lshl_add_u32 v11, v1, 4, v11
    v_add_u32 v11, s11, v11
    v_lshl_add_u32 v12, v0, 4, s11
    s_cmp_ge_u32 s7, 33
    s_cbranch_scc1 La359
    v_mov_b32 v1, 68
    s_nop 1
Lw60:
    s_sleep 1
    ds_read_b32 v2, v1
    s_waitcnt lgkmcnt(0)
    v_readfirstlane_b32 s40, v2
    s_cmp_lt_u32 s40, 4
    s_cbranch_scc1 Lw60
La359:
    v_mov_b32 v1, 52
    s_nop 1
Lw61:
    s_sleep 1
    ds_read_b32 v2, v1
    s_waitcnt lgkmcnt(0)
    v_readfirstlane_b32 s40, v2
    s_cmp_lt_u32 s40, 4
    s_cbranch_scc1 Lw61
    s_cmp_lt_u32 s7, 33
    s_mov_b32 s8, 147456
    s_cselect_b32 s8, 62208, s8
    v_lshl_add_u32 v1, v0, 4, s8
    ds_read_b128 v[56:59], v1 offset:0
    ds_read_b128 v[60:63], v1 offset:1024
    ds_read_b128 v[64:67], v1 offset:2048
    ds_read_b128 v[68:71], v1 offset:3072
    ds_read_b128 v[72:75], v1 offset:4096
    ds_read_b128 v[76:79], v1 offset:5120
    ds_read_b128 v[80:83], v1 offset:6144
    ds_read_b128 v[84:87], v1 offset:7168
    ds_read_b128 v[88:91], v1 offset:8192
    ds_read_b128 v[92:95], v1 offset:9216
    ds_read_b128 v[32:35], v1 offset:10240
    ds_read_b128 v[36:39], v1 offset:11264
    ds_read_b128 v[40:43], v1 offset:12288
    ds_read_b128 v[44:47], v1 offset:13312
    ds_read_b128 v[48:51], v1 offset:14336
    ds_read_b128 v[52:55], v1 offset:15360
    s_setprio 2
    s_cmp_lt_u32 s7, 33
    s_cbranch_scc1 La365
    s_mov_b32 s41, 32768
Lg66:
    global_load_dwordx2 v[100:101], v5, s[38:39] sc1
    global_load_dwordx2 v[102:103], v4, s[38:39] offset:512 sc1
    s_sub_u32 s41, s41, 1
    s_waitcnt vmcnt(1)
    v_bitop3_b32 v1, v100, v101, v101 bitop3:0xcf
    s_waitcnt vmcnt(0)
    v_bitop3_b32 v1, v1, v102, v103 bitop3:0xfb
    v_and_b32 v1, 1, v1
    v_cmp_ne_u32 vcc, 0, v1
    s_nop 3
    s_cbranch_scc1 Lg67
    s_cbranch_vccz Lg67
    s_sleep 8
    s_branch Lg66
Lg67:
La365:
    s_cmp_ge_u32 s3, 4
    s_cbranch_scc1 La362
    s_mov_b32 s41, 32768
Lg68:
    global_load_dwordx2 v[100:101], v4, s[38:39] offset:0 sc1
    global_load_dwordx2 v[102:103], v5, s[38:39] offset:0 sc1
    global_load_dwordx2 v[104:105], v4, s[38:39] offset:512 sc1
    global_load_dwordx2 v[106:107], v5, s[38:39] offset:512 sc1
    global_load_dwordx2 v[108:109], v4, s[38:39] offset:1024 sc1
    global_load_dwordx2 v[110:111], v5, s[38:39] offset:1024 sc1
    s_sub_u32 s41, s41, 1
    s_waitcnt vmcnt(5)
    v_bitop3_b32 v1, v100, v101, v101 bitop3:0xcf
    s_waitcnt vmcnt(4)
    v_bitop3_b32 v1, v1, v102, v103 bitop3:0xfb
    s_waitcnt vmcnt(3)
    v_bitop3_b32 v1, v1, v104, v105 bitop3:0xfb
    s_waitcnt vmcnt(2)
    v_bitop3_b32 v1, v1, v106, v107 bitop3:0xfb
    s_waitcnt vmcnt(1)
    v_bitop3_b32 v1, v1, v108, v109 bitop3:0xfb
    s_waitcnt vmcnt(0)
    v_bitop3_b32 v1, v1, v110, v111 bitop3:0xfb
    v_and_b32 v1, 1, v1
    v_cmp_ne_u32 vcc, 0, v1
    s_nop 3
    s_cbranch_scc1 Lg69
    s_cbranch_vccz Lg69
    s_sleep 8
    s_branch Lg68
Lg69:
    s_branch La363
La362:
    v_mov_b32 v109, 0
    v_mov_b32 v111, 0
    s_mov_b32 s41, 32768
    s_nop 0
Lg70:
    global_load_dwordx2 v[100:101], v4, s[38:39] offset:0 sc1
    global_load_dwordx2 v[102:103], v5, s[38:39] offset:0 sc1
    global_load_dwordx2 v[104:105], v4, s[38:39] offset:512 sc1
    global_load_dwordx2 v[106:107], v5, s[38:39] offset:512 sc1
    global_load_dword v112, v6, s[38:39] offset:0 sc1
    global_load_dword v113, v6, s[38:39] offset:32 sc1
    s_waitcnt vmcnt(1)
    v_xor_b32 v108, s12, v112
    s_waitcnt vmcnt(0)
    v_xor_b32 v110, s12, v113
    s_sub_u32 s41, s41, 1
    v_bitop3_b32 v1, v100, v101, v101 bitop3:0xcf
    v_bitop3_b32 v1, v1, v102, v103 bitop3:0xfb
    v_bitop3_b32 v1, v1, v104, v105 bitop3:0xfb
    v_bitop3_b32 v1, v1, v106, v107 bitop3:0xfb
    v_bitop3_b32 v1, v1, v108, v109 bitop3:0xfb
    v_bitop3_b32 v1, v1, v110, v111 bitop3:0xfb
    v_and_b32 v1, 1, v1
    v_cmp_ne_u32 vcc, 0, v1
    s_nop 3
    s_cbranch_scc1 Lg71
    s_cbranch_vccz Lg71
    s_sleep 8
    s_branch Lg70
Lg71:
    v_and_b32 v1, 15, v0
    v_cmp_eq_u32 vcc, 0, v1
    s_nop 1
    v_cndmask_b32 v108, 0, v112, vcc
    v_cndmask_b32 v110, 0, v113, vcc
    s_nop 1
La363:
    v_mfma_f32_16x16x32_bf16 v[124:127], v[100:103], v[24:27], 0
    v_mfma_f32_16x16x32_bf16 v[128:131], v[100:103], v[28:31], 0
    v_mfma_f32_16x16x32_bf16 v[132:135], v[104:107], v[24:27], 0
    v_mfma_f32_16x16x32_bf16 v[136:139], v[104:107], v[28:31], 0
    v_mfma_f32_16x16x32_bf16 v[140:143], v[108:111], v[24:27], 0
    v_mfma_f32_16x16x32_bf16 v[144:147], v[108:111], v[28:31], 0
    s_nop 2
    v_cvt_pk_bf16_f32 v100, v124, v125
    v_cvt_pk_bf16_f32 v101, v126, v127
    ds_write_b64 v7, v[100:101] offset:0
    v_cvt_pk_bf16_f32 v102, v128, v129
    v_cvt_pk_bf16_f32 v103, v130, v131
    ds_write_b64 v7, v[102:103] offset:704
    v_cvt_pk_bf16_f32 v104, v132, v133
    v_cvt_pk_bf16_f32 v105, v134, v135
    ds_write_b64 v7, v[104:105] offset:256
    v_cvt_pk_bf16_f32 v106, v136, v137
    v_cvt_pk_bf16_f32 v107, v138, v139
    ds_write_b64 v7, v[106:107] offset:960
    s_cmp_ge_u32 s3, 6
    s_cbranch_scc1 La364
    v_cvt_pk_bf16_f32 v108, v140, v141
    v_cvt_pk_bf16_f32 v109, v142, v143
    ds_write_b64 v7, v[108:109] offset:512
    v_cvt_pk_bf16_f32 v110, v144, v145
    v_cvt_pk_bf16_f32 v111, v146, v147
    ds_write_b64 v7, v[110:111] offset:1216
    s_nop 0
La364:
    v_mov_b32 v1, 16
    v_mov_b32 v2, 1
    s_waitcnt lgkmcnt(0)
    s_mov_b64 exec, 1
    ds_add_rtn_u32 v2, v1, v2
    s_mov_b64 exec, -1
    s_waitcnt lgkmcnt(0)
    v_readfirstlane_b32 s40, v2
    s_cmp_ge_u32 s40, 7
    s_cbranch_scc1 Lbd72
Lbl73:
    ds_read_b32 v2, v1
    s_waitcnt lgkmcnt(0)
    v_readfirstlane_b32 s40, v2
    s_cmp_lt_u32 s40, 8
    s_cbranch_scc1 Lbl73
Lbd72:
    ds_read_b64_tr_b16 v[108:109], v10 offset:0
    ds_read_b64_tr_b16 v[110:111], v10 offset:704
    ds_read_b64_tr_b16 v[100:101], v8 offset:0
    ds_read_b64_tr_b16 v[102:103], v8 offset:704
    ds_read_b64_tr_b16 v[104:105], v9 offset:0
    ds_read_b64_tr_b16 v[106:107], v9 offset:704
    s_waitcnt lgkmcnt(4)
    v_mfma_f32_16x16x32_bf16 v[140:143], v[108:111], v[16:19], 0
    v_mfma_f32_16x16x32_bf16 v[144:147], v[108:111], v[20:23], 0
    s_waitcnt lgkmcnt(2)
    v_mfma_f32_16x16x32_bf16 v[124:127], v[100:103], v[16:19], 0
    v_mfma_f32_16x16x32_bf16 v[128:131], v[100:103], v[20:23], 0
    s_waitcnt lgkmcnt(0)
    v_mfma_f32_16x16x32_bf16 v[132:135], v[104:107], v[16:19], 0
    v_mfma_f32_16x16x32_bf16 v[136:139], v[104:107], v[20:23], 0
    s_nop 0
    v_mul_f32 v112, v140, v48
    v_mul_f32 v116, v144, v48
    v_fma_f32 v112, -v144, v52, v112
    v_fmac_f32 v116, v140, v52
    v_mul_f32 v113, v141, v49
    v_mul_f32 v117, v145, v49
    v_fma_f32 v113, -v145, v53, v113
    v_fmac_f32 v117, v141, v53
    v_cvt_pk_bf16_f32 v108, v112, v113
    v_cvt_pk_bf16_f32 v110, v116, v117
    v_mul_f32 v114, v142, v50
    v_mul_f32 v118, v146, v50
    v_fma_f32 v114, -v146, v54, v114
    v_fmac_f32 v118, v142, v54
    v_mul_f32 v115, v143, v51
    v_mul_f32 v119, v147, v51
    v_fma_f32 v115, -v147, v55, v115
    v_fmac_f32 v119, v143, v55
    v_cvt_pk_bf16_f32 v109, v114, v115
    v_cvt_pk_bf16_f32 v111, v118, v119
    s_nop 1
    v_mfma_f32_16x16x32_bf16 v[120:123], v[108:111], v[96:99], 0
    v_mul_f32 v112, v124, v32
    v_mul_f32 v116, v128, v32
    v_fma_f32 v112, -v128, v36, v112
    v_fmac_f32 v116, v124, v36
    v_mul_f32 v113, v125, v33
    v_mul_f32 v117, v129, v33
    v_fma_f32 v113, -v129, v37, v113
    v_fmac_f32 v117, v125, v37
    v_cvt_pk_bf16_f32 v100, v112, v113
    v_cvt_pk_bf16_f32 v102, v116, v117
    v_mul_f32 v114, v126, v34
    v_mul_f32 v118, v130, v34
    v_fma_f32 v114, -v130, v38, v114
    v_fmac_f32 v118, v126, v38
    v_mul_f32 v115, v127, v35
    v_mul_f32 v119, v131, v35
    v_fma_f32 v115, -v131, v39, v115
    v_fmac_f32 v119, v127, v39
    v_cvt_pk_bf16_f32 v101, v114, v115
    v_cvt_pk_bf16_f32 v103, v118, v119
    s_nop 1
    v_mfma_f32_16x16x32_bf16 v[148:151], v[100:103], v[56:59], v[120:123]
    v_mfma_f32_16x16x32_bf16 v[152:155], v[100:103], v[60:63], v[120:123]
    v_mfma_f32_16x16x32_bf16 v[156:159], v[100:103], v[64:67], v[120:123]
    v_mfma_f32_16x16x32_bf16 v[160:163], v[100:103], v[68:71], v[120:123]
    v_mfma_f32_16x16x32_bf16 v[164:167], v[100:103], v[72:75], v[120:123]
    v_mul_f32 v112, v132, v40
    v_mul_f32 v116, v136, v40
    v_fma_f32 v112, -v136, v44, v112
    v_fmac_f32 v116, v132, v44
    v_mul_f32 v113, v133, v41
    v_mul_f32 v117, v137, v41
    v_fma_f32 v113, -v137, v45, v113
    v_fmac_f32 v117, v133, v45
    v_cvt_pk_bf16_f32 v104, v112, v113
    v_cvt_pk_bf16_f32 v106, v116, v117
    v_mul_f32 v114, v134, v42
    v_mul_f32 v118, v138, v42
    v_fma_f32 v114, -v138, v46, v114
    v_fmac_f32 v118, v134, v46
    v_mul_f32 v115, v135, v43
    v_mul_f32 v119, v139, v43
    v_fma_f32 v115, -v139, v47, v115
    v_fmac_f32 v119, v135, v47
    v_cvt_pk_bf16_f32 v105, v114, v115
    v_cvt_pk_bf16_f32 v107, v118, v119
    s_nop 1
    v_mfma_f32_16x16x32_bf16 v[148:151], v[104:107], v[76:79], v[148:151]
    v_mfma_f32_16x16x32_bf16 v[152:155], v[104:107], v[80:83], v[152:155]
    v_mfma_f32_16x16x32_bf16 v[156:159], v[104:107], v[84:87], v[156:159]
    v_mfma_f32_16x16x32_bf16 v[160:163], v[104:107], v[88:91], v[160:163]
    v_mfma_f32_16x16x32_bf16 v[164:167], v[104:107], v[92:95], v[164:167]
    s_nop 3
    v_cvt_pk_bf16_f32 v124, v148, v149
    v_cvt_pk_bf16_f32 v125, v150, v151
    ds_write_b64 v11, v[124:125] offset:0
    v_cvt_pk_bf16_f32 v126, v152, v153
    v_cvt_pk_bf16_f32 v127, v154, v155
    ds_write_b64 v11, v[126:127] offset:256
    v_cvt_pk_bf16_f32 v128, v156, v157
    v_cvt_pk_bf16_f32 v129, v158, v159
    ds_write_b64 v11, v[128:129] offset:512
    v_cvt_pk_bf16_f32 v130, v160, v161
    v_cvt_pk_bf16_f32 v131, v162, v163
    ds_write_b64 v11, v[130:131] offset:768
    v_cvt_pk_bf16_f32 v132, v164, v165
    v_cvt_pk_bf16_f32 v133, v166, v167
    ds_write_b64 v11, v[132:133] offset:1024
    ds_read_b128 v[100:103], v12 offset:0
    ds_read_b128 v[104:107], v12 offset:1024
    ds_read_b128 v[108:111], v12 offset:2048
    s_waitcnt lgkmcnt(2)
    global_store_dwordx4 v13, v[100:103], s[34:35] sc1
    s_mov_b32 exec_lo, 4278255615
    s_waitcnt lgkmcnt(1)
    global_store_dwordx4 v14, v[104:107], s[34:35] offset:1024 sc1
    s_mov_b32 exec_lo, -1
    s_mov_b32 exec_hi, 255
    s_waitcnt lgkmcnt(0)
    global_store_dwordx4 v15, v[108:111], s[34:35] offset:2048 sc1
    s_mov_b64 exec, -1
    s_branch Lfin
LB3:
    s_cmp_ge_u32 s3, 10
    s_cbranch_scc1 Lfin
    s_cmp_ge_u32 s3, 5
    s_cselect_b32 s13, 1, 0
    s_mul_i32 s14, s13, 5
    s_sub_u32 s14, s3, s14
    v_lshrrev_b32 v5, 3, v0
    v_lshl_add_u32 v5, s14, 3, v5
    v_and_b32 v6, 7, v0
    s_lshl_b32 s15, s13, 3
    s_add_u32 s15, s15, 7
    v_sub_u32 v6, s15, v6
    v_mul_u32_u24 v3, 1296, v6
    v_lshl_add_u32 v3, v5, 2, v3
    v_add_u32 v3, 116224, v3
    s_mul_i32 s15, s4, 327680
    s_add_u32 s15, s15, 3149808
    s_lshl_b32 s8, s6, 8
    s_sub_u32 s15, s15, s8
    v_lshl_add_u32 v4, v5, 13, s15
    v_lshlrev_b32 v7, 4, v6
    v_sub_u32 v4, v4, v7
    v_add_u32 v8, 4096, v4
    v_mov_b32 v20, 4294901760
    v_mov_b32 v1, 92
    s_nop 1
Lw74:
    s_sleep 1
    ds_read_b32 v2, v1
    s_waitcnt lgkmcnt(0)
    v_readfirstlane_b32 s40, v2
    s_cmp_lt_u32 s40, 6
    s_cbranch_scc1 Lw74
    s_setprio 2
    global_load_dwordx4 v[10:13], v4, s[38:39] sc1
    global_load_dwordx4 v[14:17], v8, s[38:39] sc1
    v_mul_u32_u24 v1, 26, v0
    v_lshrrev_b32 v1, 8, v1
    v_mul_u32_u24 v18, 2400, v1
    v_lshl_add_u32 v18, v0, 4, v18
    s_lshl_b32 s8, s6, 3
    s_add_u32 s8, s8, s3
    s_mul_i32 s8, s8, 40960
    s_mul_i32 s9, s4, 160
    s_add_u32 s8, s8, s9
    s_add_u32 s8, s8, 1280
    v_add_u32 v18, s8, v18
    s_mul_i32 s8, s3, 2592
    s_add_u32 s8, s8, 138256
    v_lshl_add_u32 v19, v0, 4, s8
    v_mov_b32 v1, 36
    s_nop 1
Lbl75:
    ds_read_b32 v2, v1
    s_waitcnt lgkmcnt(0)
    v_readfirstlane_b32 s40, v2
    s_cmp_lt_u32 s40, 8
    s_cbranch_scc1 Lbl75
Lbd76:
    ds_read_b32 v22, v3 offset:22032
    ds_read_b32 v23, v3 offset:22192
    ds_read_b32 v24, v3 offset:22352
    ds_read_b32 v25, v3 offset:22512
    ds_read_b32 v26, v3 offset:22672
    ds_read_b32 v27, v3 offset:22832
    ds_read_b32 v28, v3 offset:22992
    ds_read_b32 v29, v3 offset:23152
    s_waitcnt lgkmcnt(7)
    v_lshlrev_b32 v30, 16, v22
    v_and_b32 v31, v20, v22
    s_waitcnt lgkmcnt(6)
    v_lshlrev_b32 v32, 16, v23
    v_and_b32 v33, v20, v23
    s_waitcnt lgkmcnt(5)
    v_lshlrev_b32 v34, 16, v24
    v_and_b32 v35, v20, v24
    s_waitcnt lgkmcnt(4)
    v_lshlrev_b32 v36, 16, v25
    v_and_b32 v37, v20, v25
    s_waitcnt lgkmcnt(3)
    v_lshlrev_b32 v38, 16, v26
    v_and_b32 v39, v20, v26
    s_waitcnt lgkmcnt(2)
    v_lshlrev_b32 v40, 16, v27
    v_and_b32 v41, v20, v27
    s_waitcnt lgkmcnt(1)
    v_lshlrev_b32 v42, 16, v28
    v_and_b32 v43, v20, v28
    s_waitcnt lgkmcnt(0)
    v_lshlrev_b32 v44, 16, v29
    v_and_b32 v45, v20, v29
    s_mov_b32 s41, 32768
    s_branch Lg79
Lg77:
    s_waitcnt vmcnt(1)
    global_load_dwordx4 v[10:13], v4, s[38:39] sc1
    s_waitcnt vmcnt(1)
    global_load_dwordx4 v[14:17], v8, s[38:39] sc1
Lg79:
    s_sub_u32 s41, s41, 1
    s_waitcnt vmcnt(0)
    v_bitop3_b32 v1, v10, v11, v11 bitop3:0xcf
    v_bitop3_b32 v1, v1, v12, v13 bitop3:0xfb
    v_bitop3_b32 v1, v1, v14, v15 bitop3:0xfb
    v_bitop3_b32 v1, v1, v16, v17 bitop3:0xfb
    v_and_b32 v1, 1, v1
    v_cmp_ne_u32 vcc, 0, v1
    s_nop 3
    s_cbranch_scc1 Lg78
    s_cbranch_vccz Lg78
    s_sleep 8
    s_branch Lg77
Lg78:
    v_and_b32 v46, v20, v13
    v_mul_f32 v46, v46, v30
    v_and_b32 v47, v20, v17
    v_mul_f32 v47, v47, v31
    v_cvt_pk_bf16_f32 v22, v46, v47
    ds_write_b32 v3, v22 offset:22032
    v_lshlrev_b32 v46, 16, v13
    v_mul_f32 v46, v46, v32
    v_lshlrev_b32 v47, 16, v17
    v_mul_f32 v47, v47, v33
    v_cvt_pk_bf16_f32 v23, v46, v47
    ds_write_b32 v3, v23 offset:22192
    v_and_b32 v46, v20, v12
    v_mul_f32 v46, v46, v34
    v_and_b32 v47, v20, v16
    v_mul_f32 v47, v47, v35
    v_cvt_pk_bf16_f32 v24, v46, v47
    ds_write_b32 v3, v24 offset:22352
    v_lshlrev_b32 v46, 16, v12
    v_mul_f32 v46, v46, v36
    v_lshlrev_b32 v47, 16, v16
    v_mul_f32 v47, v47, v37
    v_cvt_pk_bf16_f32 v25, v46, v47
    ds_write_b32 v3, v25 offset:22512
    v_and_b32 v46, v20, v11
    v_mul_f32 v46, v46, v38
    v_and_b32 v47, v20, v15
    v_mul_f32 v47, v47, v39
    v_cvt_pk_bf16_f32 v26, v46, v47
    ds_write_b32 v3, v26 offset:22672
    v_lshlrev_b32 v46, 16, v11
    v_mul_f32 v46, v46, v40
    v_lshlrev_b32 v47, 16, v15
    v_mul_f32 v47, v47, v41
    v_cvt_pk_bf16_f32 v27, v46, v47
    ds_write_b32 v3, v27 offset:22832
    v_and_b32 v46, v20, v10
    v_mul_f32 v46, v46, v42
    v_and_b32 v47, v20, v14
    v_mul_f32 v47, v47, v43
    v_cvt_pk_bf16_f32 v28, v46, v47
    ds_write_b32 v3, v28 offset:22992
    v_lshlrev_b32 v46, 16, v10
    v_mul_f32 v46, v46, v44
    v_lshlrev_b32 v47, 16, v14
    v_mul_f32 v47, v47, v45
    v_cvt_pk_bf16_f32 v29, v46, v47
    ds_write_b32 v3, v29 offset:23152
    v_mov_b32 v1, 32
    v_mov_b32 v2, 1
    s_waitcnt lgkmcnt(0)
    s_mov_b64 exec, 1
    ds_add_rtn_u32 v2, v1, v2
    s_mov_b64 exec, -1
    s_waitcnt lgkmcnt(0)
    v_readfirstlane_b32 s40, v2
    s_cmp_ge_u32 s40, 9
    s_cbranch_scc1 Lbd80
Lbl81:
    ds_read_b32 v2, v1
    s_waitcnt lgkmcnt(0)
    v_readfirstlane_b32 s40, v2
    s_cmp_lt_u32 s40, 10
    s_cbranch_scc1 Lbl81
Lbd80:
    s_cmp_ge_u32 s3, 8
    s_cbranch_scc1 Lfin
    s_mov_b32 exec_hi, 255
    ds_read_b128 v[50:53], v19 offset:0
    ds_read_b128 v[54:57], v19 offset:640
    ds_read_b128 v[58:61], v19 offset:1296
    ds_read_b128 v[62:65], v19 offset:1936
    s_waitcnt lgkmcnt(3)
    global_store_dwordx4 v18, v[50:53], s[34:35] sc1
    v_add_u32 v18, 10240, v18
    s_waitcnt lgkmcnt(2)
    global_store_dwordx4 v18, v[54:57], s[34:35] sc1
    v_add_u32 v18, 10240, v18
    s_waitcnt lgkmcnt(1)
    global_store_dwordx4 v18, v[58:61], s[34:35] sc1
    v_add_u32 v18, 10240, v18
    s_waitcnt lgkmcnt(0)
    global_store_dwordx4 v18, v[62:65], s[34:35] sc1
    s_mov_b64 exec, -1
    s_nop 0
Lfin:
    s_endpgm
.p2align 10
.section .rodata,"a"
.p2align 6
.amdhsa_kernel concat_heads__spectral_gfnet__ssm_conv_h3__prompt_kernel
  .amdhsa_next_free_vgpr 168
  .amdhsa_next_free_sgpr 102
  .amdhsa_accum_offset 168
  .amdhsa_group_segment_fixed_size 0
  .amdhsa_float_denorm_mode_32 3
  .amdhsa_kernarg_size 96
  .amdhsa_user_sgpr_count 2
  .amdhsa_user_sgpr_kernarg_segment_ptr 1
  .amdhsa_system_sgpr_workgroup_id_x 1
.end_amdhsa_kernel
.text
```
